```python
import torch

def _softmax(x, axis=-1):
    return torch.softmax(x, dim=axis)

def _gelu(x):
    return torch.nn.functional.gelu(x, approximate='tanh')

def _silu(x):
    return torch.nn.functional.silu(x)

def _sigmoid(x):
    return torch.sigmoid(x)

def _layernorm(x, axis=-1, eps=1e-05):
    m = x.mean(dim=axis, keepdim=True)
    v = x.var(dim=axis, keepdim=True, unbiased=False)
    return (x - m) / torch.sqrt(v + eps)

def _scatter_add(tgt, idx, src, axis=0):
    return tgt.clone().index_add_(axis, idx, src)

def _segment_sum(src, seg, n):
    out = torch.zeros((n,) + src.shape[1:], dtype=src.dtype)
    return out.index_add_(0, seg, src)

def _pad(x, pw):
    flat = tuple((v for pair in reversed(pw) for v in pair))
    return torch.nn.functional.pad(x, flat)
kernel_name = 'gated_mix__memory_aug_recurrent_mem_tr__grouped_kv_mqa__prompt'

def setup_inputs():

    _w = lambda a: (lambda t: t.to(torch.bfloat16) if t.is_floating_point() else t)(torch.as_tensor(a))

    def _A_setup():
        B, S, Dm = (1, 2048, 512)
        H, Dh = (32, 128)
        M, seg = (8, 32)
        seg = min(seg, S)
        S = S // seg * seg
        return {'x': _w((lambda *s: torch.randn(*s, dtype=torch.bfloat16) * 0.05)(B, S, Dm)), 'mem0': _w((lambda *s: torch.randn(*s, dtype=torch.bfloat16) * 0.8)(B, M, Dm)), 'Wq': _w((lambda *s: torch.randn(*s, dtype=torch.bfloat16) * 1.6)(Dm, H, Dh) * Dm ** (-0.5)), 'Wk': _w((lambda *s: torch.randn(*s, dtype=torch.bfloat16) * 1.6)(Dm, H, Dh) * Dm ** (-0.5)), 'Wv': _w((lambda *s: torch.randn(*s, dtype=torch.bfloat16) * 0.8)(Dm, H, Dh) * Dm ** (-0.5)), 'Wo': _w((lambda *s: torch.randn(*s, dtype=torch.bfloat16) * 0.8)(H, Dh, Dm) * (H * Dh) ** (-0.5)), 'seg_len': seg}
    _A_in = _A_setup()

    def _B_setup():
        B, S, D, H = (1, 2048, 512, 32)
        Dh = D // H
        return {'x': _w((lambda *s: torch.randn(*s, dtype=torch.bfloat16) * 0.05)(B, S, D)), 'wq': _w((lambda *s: torch.randn(*s, dtype=torch.bfloat16) * 1.6)(D, H * Dh)), 'wk': _w((lambda *s: torch.randn(*s, dtype=torch.bfloat16) * 1.6)(D, Dh)), 'wv': _w((lambda *s: torch.randn(*s, dtype=torch.bfloat16) * 0.05)(D, Dh)), 'wo': _w((lambda *s: torch.randn(*s, dtype=torch.bfloat16) * 0.05)(H * Dh, D))}
    _B_in = _B_setup()
    return {'A_x': _A_in['x'], 'A_mem0': _A_in['mem0'], 'A_Wq': _A_in['Wq'], 'A_Wk': _A_in['Wk'], 'A_Wv': _A_in['Wv'], 'A_Wo': _A_in['Wo'], 'A_seg_len': _A_in['seg_len'], 'B_x': _B_in['x'], 'B_wq': _B_in['wq'], 'B_wk': _B_in['wk'], 'B_wv': _B_in['wv'], 'B_wo': _B_in['wo'], 'gate_w': _w((lambda *s: torch.randn(*s, dtype=torch.bfloat16) * 0.05)(512) * 16.0)}

def reference(A_x, A_mem0, A_Wq, A_Wk, A_Wv, A_Wo, A_seg_len, B_x, B_wq, B_wk, B_wv, B_wo, gate_w):

    def _A_ref(x, mem0, Wq, Wk, Wv, Wo, seg_len):
        B, S, Dm = x.shape
        H, Dh = (Wq.shape[1], Wq.shape[2])
        M = mem0.shape[1]
        scale = Dh ** (-0.5)
        n_seg = S // seg_len
        L = M + seg_len
        idx = torch.arange(L)
        mask = (idx[:, None] < M) | (idx[:, None] >= idx[None, :])
        mem = mem0
        outs = []
        for s in range(n_seg):
            xs = x[:, s * seg_len:(s + 1) * seg_len, :].clone()
            h = torch.concatenate([mem, xs], axis=1)
            q = torch.einsum('btd,dhe->bhte', h, Wq)
            k = torch.einsum('btd,dhe->bhte', h, Wk)
            v = torch.einsum('btd,dhe->bhte', h, Wv)
            scores = torch.einsum('bhqe,bhke->bhqk', q, k) * scale
            scores = torch.where(mask[None, None], scores, -1000000000.0)
            p = _softmax(scores, axis=-1)
            o = torch.einsum('bhqk,bhke->bhqe', p, v)
            o = torch.einsum('bhte,hed->btd', o, Wo)
            mem = o[:, :M, :].clone()
            outs.append(o[:, M:, :])
        return torch.concatenate(outs, axis=1)

    def _B_ref(x, wq, wk, wv, wo):
        B, S, D = x.shape
        H = 32
        Dh = D // H
        q = (lambda x, *d: x.permute(*d))((x @ wq).reshape(B, S, H, Dh), 0, 2, 1, 3)
        k = x @ wk
        v = x @ wv
        scores = torch.einsum('bhqd,bkd->bhqk', q, k) * Dh ** (-0.5)
        p = _softmax(scores, axis=-1)
        o = torch.einsum('bhqk,bkd->bhqd', p, v)
        return (lambda x, *d: x.permute(*d))(o, 0, 2, 1, 3).reshape(B, S, H * Dh) @ wo
    x = A_x
    g = _sigmoid((x * gate_w).sum(-1, keepdims=True))
    a = _A_ref(x, A_mem0, A_Wq, A_Wk, A_Wv, A_Wo, A_seg_len)
    b = _B_ref(x, B_wq, B_wk, B_wv, B_wo)
    return g * a + (1 - g) * b
```

```asm
; @launch grid=(256,1,1) block=(256,1,1) lds=163840
  .amdgcn_target "amdgcn-amd-amdhsa--gfx950"
  .text
  .globl gated_mix__memory_aug_recurrent_mem_tr__grouped_kv_mqa__prompt_kernel
  .p2align 8
  .type gated_mix__memory_aug_recurrent_mem_tr__grouped_kv_mqa__prompt_kernel,@function
gated_mix__memory_aug_recurrent_mem_tr__grouped_kv_mqa__prompt_kernel:
  s_cmp_ge_u32 s2, 256
  s_cbranch_scc1 K_END
  s_load_dwordx4 s[64:67], s[0:1], 0
  s_load_dwordx4 s[68:71], s[0:1], 16
  s_load_dwordx4 s[72:75], s[0:1], 32
  s_load_dwordx4 s[76:79], s[0:1], 64
  s_load_dwordx4 s[80:83], s[0:1], 80
  s_load_dwordx4 s[84:87], s[0:1], 96
  s_load_dwordx4 s[88:91], s[0:1], 112
  v_lshrrev_b32 v1, 6, v0
  v_and_b32 v0, 63, v0
  s_nop 0
  v_readfirstlane_b32 s21, v1
  s_waitcnt lgkmcnt(0)
  s_mov_b32 s8, s90
  s_and_b32 s9, s91, 0xffff
  s_mov_b32 s10, 0x10000000
  s_mov_b32 s11, 0x20000
  s_mov_b32 s16, s88
  s_and_b32 s17, s89, 0xffff
  s_mov_b32 s18, 0x100
  s_mov_b32 s19, 0x20000
  s_mov_b32 s96, 0
  s_mov_b32 s97, 0
  s_getreg_b32 s92, hwreg(HW_REG_XCC_ID, 0, 4)
  s_cmp_eq_u32 s21, 0
  s_cbranch_scc0 RA_WAIT
  s_lshl_b32 s93, s92, 2
  v_mov_b32 v1, s93
  v_mov_b32 v2, 1
  s_mov_b64 exec, 1
  buffer_atomic_add v2, v1, s[16:19], 0 offen sc0
  s_waitcnt vmcnt(0)
  v_mov_b32 v1, 0
  ds_write_b32 v1, v2
  s_waitcnt lgkmcnt(0)
  s_mov_b64 exec, -1
RA_WAIT:
  s_barrier
  v_mov_b32 v1, 0
  ds_read_b32 v2, v1
  s_waitcnt lgkmcnt(0)
  v_readfirstlane_b32 s20, v2
  s_nop 3
  s_barrier
  s_cmp_ge_u32 s20, 32
  s_cbranch_scc1 K_END
  s_cmp_ge_u32 s92, 8
  s_cbranch_scc1 K_END
  s_lshl_b32 s95, s92, 5
  s_add_u32 s95, s95, s20
  s_sub_u32 s94, s95, 32
  s_cmp_eq_u32 s92, 0
  s_cbranch_scc0 K_WORKER
  v_lshlrev_b32 v1, 4, v0
  s_lshl_b32 s40, s21, 15
  v_add_u32 v11, s40, v1
  v_bfe_u32 v22, v0, 2, 4
  v_lshlrev_b32 v40, 13, v22
  v_bfe_u32 v22, v0, 0, 2
  v_lshl_add_u32 v40, v22, 4, v40
  v_bfe_u32 v22, v0, 3, 3
  v_lshlrev_b32 v41, 10, v22
  v_bfe_u32 v22, v0, 0, 3
  v_lshl_add_u32 v41, v22, 4, v41
  s_lshl_b32 s40, s21, 13
  s_add_u32 s40, s40, 131072
  v_bfe_u32 v22, v0, 1, 1
  v_lshlrev_b32 v42, 8, v22
  v_bfe_u32 v22, v0, 2, 1
  v_lshl_add_u32 v42, v22, 9, v42
  v_bfe_u32 v22, v0, 4, 1
  v_lshl_add_u32 v42, v22, 10, v42
  v_bfe_u32 v22, v0, 5, 1
  v_lshl_add_u32 v42, v22, 11, v42
  v_bfe_u32 v22, v0, 3, 1
  v_lshl_add_u32 v42, v22, 5, v42
  v_bfe_u32 v22, v0, 1, 1
  v_lshl_add_u32 v42, v22, 6, v42
  v_bfe_u32 v22, v0, 2, 1
  v_lshl_add_u32 v42, v22, 7, v42
  v_bfe_u32 v22, v0, 0, 1
  v_lshl_add_u32 v42, v22, 4, v42
  v_add_u32 v42, s40, v42
  v_xor_b32 v43, 64, v42
  v_xor_b32 v44, 128, v42
  v_xor_b32 v45, 192, v42
  v_bfe_u32 v22, v0, 5, 1
  v_lshlrev_b32 v46, 10, v22
  v_bfe_u32 v22, v0, 4, 1
  v_lshl_add_u32 v46, v22, 5, v46
  v_bfe_u32 v22, v0, 2, 1
  v_lshl_add_u32 v46, v22, 6, v46
  v_bfe_u32 v22, v0, 3, 1
  v_lshl_add_u32 v46, v22, 7, v46
  v_bfe_u32 v22, v0, 0, 2
  v_lshl_add_u32 v46, v22, 3, v46
  v_add_u32 v46, s40, v46
  v_xor_b32 v47, 64, v46
  v_xor_b32 v48, 128, v46
  v_xor_b32 v49, 192, v46
  v_bfe_u32 v22, v0, 1, 2
  v_lshlrev_b32 v50, 8, v22
  v_bfe_u32 v22, v0, 4, 1
  v_lshl_add_u32 v50, v22, 10, v50
  v_bfe_u32 v22, v0, 3, 1
  v_lshl_add_u32 v50, v22, 5, v50
  v_bfe_u32 v22, v0, 5, 1
  v_lshl_add_u32 v50, v22, 6, v50
  v_bfe_u32 v22, v0, 0, 1
  v_lshl_add_u32 v50, v22, 4, v50
  v_add_u32 v50, s40, v50
  v_bfe_u32 v22, v0, 5, 1
  v_lshlrev_b32 v51, 11, v22
  v_bfe_u32 v22, v0, 2, 1
  v_lshl_add_u32 v51, v22, 5, v51
  v_bfe_u32 v22, v0, 4, 1
  v_lshl_add_u32 v51, v22, 6, v51
  v_bfe_u32 v22, v0, 3, 1
  v_lshl_add_u32 v51, v22, 7, v51
  v_bfe_u32 v22, v0, 0, 2
  v_lshl_add_u32 v51, v22, 3, v51
  v_add_u32 v51, s40, v51
  s_mov_b32 s48, s68
  s_and_b32 s49, s69, 0xffff
  s_mov_b32 s50, 0x400000
  s_mov_b32 s51, 0x20000
  s_mov_b32 s52, s70
  s_and_b32 s53, s71, 0xffff
  s_mov_b32 s54, 0x400000
  s_mov_b32 s55, 0x20000
  s_mov_b32 s56, s72
  s_and_b32 s57, s73, 0xffff
  s_mov_b32 s58, 0x400000
  s_mov_b32 s59, 0x20000
  s_mov_b32 s60, s74
  s_and_b32 s61, s75, 0xffff
  s_mov_b32 s62, 0x400000
  s_mov_b32 s63, 0x20000
  s_lshl_b32 s40, s20, 17
  s_lshl_b32 s41, s21, 8
  s_add_u32 s40, s40, s41
  s_add_u32 s40, s40, 128
  buffer_load_dwordx4 a[64:67], v41, s[60:63], s40 offen
  s_add_u32 s40, s40, 8192
  buffer_load_dwordx4 a[68:71], v41, s[60:63], s40 offen
  s_add_u32 s40, s40, 8192
  buffer_load_dwordx4 a[72:75], v41, s[60:63], s40 offen
  s_add_u32 s40, s40, 8192
  buffer_load_dwordx4 a[76:79], v41, s[60:63], s40 offen
  s_add_u32 s40, s40, 8192
  buffer_load_dwordx4 a[80:83], v41, s[60:63], s40 offen
  s_add_u32 s40, s40, 8192
  buffer_load_dwordx4 a[84:87], v41, s[60:63], s40 offen
  s_add_u32 s40, s40, 8192
  buffer_load_dwordx4 a[88:91], v41, s[60:63], s40 offen
  s_add_u32 s40, s40, 8192
  buffer_load_dwordx4 a[92:95], v41, s[60:63], s40 offen
  s_lshl_b32 s40, s20, 17
  s_lshl_b32 s41, s21, 8
  s_add_u32 s40, s40, s41
  s_add_u32 s40, s40, 65664
  buffer_load_dwordx4 a[96:99], v41, s[60:63], s40 offen
  s_add_u32 s40, s40, 8192
  buffer_load_dwordx4 a[100:103], v41, s[60:63], s40 offen
  s_add_u32 s40, s40, 8192
  buffer_load_dwordx4 a[104:107], v41, s[60:63], s40 offen
  s_add_u32 s40, s40, 8192
  buffer_load_dwordx4 a[108:111], v41, s[60:63], s40 offen
  s_add_u32 s40, s40, 8192
  buffer_load_dwordx4 a[112:115], v41, s[60:63], s40 offen
  s_add_u32 s40, s40, 8192
  buffer_load_dwordx4 a[116:119], v41, s[60:63], s40 offen
  s_add_u32 s40, s40, 8192
  buffer_load_dwordx4 a[120:123], v41, s[60:63], s40 offen
  s_add_u32 s40, s40, 8192
  buffer_load_dwordx4 a[124:127], v41, s[60:63], s40 offen
  s_lshl_b32 s40, s20, 17
  s_lshl_b32 s41, s21, 8
  s_add_u32 s40, s40, s41
  s_add_u32 s40, s40, 0
  buffer_load_dwordx4 v[128:131], v41, s[60:63], s40 offen
  s_add_u32 s40, s40, 8192
  buffer_load_dwordx4 v[132:135], v41, s[60:63], s40 offen
  s_add_u32 s40, s40, 8192
  buffer_load_dwordx4 v[136:139], v41, s[60:63], s40 offen
  s_add_u32 s40, s40, 8192
  buffer_load_dwordx4 v[140:143], v41, s[60:63], s40 offen
  s_add_u32 s40, s40, 8192
  buffer_load_dwordx4 v[144:147], v41, s[60:63], s40 offen
  s_add_u32 s40, s40, 8192
  buffer_load_dwordx4 v[148:151], v41, s[60:63], s40 offen
  s_add_u32 s40, s40, 8192
  buffer_load_dwordx4 v[152:155], v41, s[60:63], s40 offen
  s_add_u32 s40, s40, 8192
  buffer_load_dwordx4 v[156:159], v41, s[60:63], s40 offen
  s_lshl_b32 s40, s20, 17
  s_lshl_b32 s41, s21, 8
  s_add_u32 s40, s40, s41
  s_add_u32 s40, s40, 65536
  buffer_load_dwordx4 v[160:163], v41, s[60:63], s40 offen
  s_add_u32 s40, s40, 8192
  buffer_load_dwordx4 v[164:167], v41, s[60:63], s40 offen
  s_add_u32 s40, s40, 8192
  buffer_load_dwordx4 v[168:171], v41, s[60:63], s40 offen
  s_add_u32 s40, s40, 8192
  buffer_load_dwordx4 v[172:175], v41, s[60:63], s40 offen
  s_add_u32 s40, s40, 8192
  buffer_load_dwordx4 v[176:179], v41, s[60:63], s40 offen
  s_add_u32 s40, s40, 8192
  buffer_load_dwordx4 v[180:183], v41, s[60:63], s40 offen
  s_add_u32 s40, s40, 8192
  buffer_load_dwordx4 v[184:187], v41, s[60:63], s40 offen
  s_add_u32 s40, s40, 8192
  buffer_load_dwordx4 v[188:191], v41, s[60:63], s40 offen
  s_xor_b32 s40, s21, 0
  s_lshl_b32 s40, s40, 20
  s_lshl_b32 s41, s20, 8
  s_add_u32 s40, s40, s41
  s_lshl_b32 s41, s21, 6
  s_add_u32 s40, s40, s41
  buffer_load_dwordx4 a[0:3], v40, s[48:51], s40 offen
  s_add_u32 s40, s40, 131072
  buffer_load_dwordx4 a[4:7], v40, s[48:51], s40 offen
  s_add_u32 s40, s40, 131072
  buffer_load_dwordx4 a[8:11], v40, s[48:51], s40 offen
  s_add_u32 s40, s40, 131072
  buffer_load_dwordx4 a[12:15], v40, s[48:51], s40 offen
  s_add_u32 s40, s40, 131072
  buffer_load_dwordx4 a[16:19], v40, s[48:51], s40 offen
  s_add_u32 s40, s40, 131072
  buffer_load_dwordx4 a[20:23], v40, s[48:51], s40 offen
  s_add_u32 s40, s40, 131072
  buffer_load_dwordx4 a[24:27], v40, s[48:51], s40 offen
  s_add_u32 s40, s40, 131072
  buffer_load_dwordx4 a[28:31], v40, s[48:51], s40 offen
  s_xor_b32 s40, s21, 1
  s_lshl_b32 s40, s40, 20
  s_lshl_b32 s41, s20, 8
  s_add_u32 s40, s40, s41
  s_lshl_b32 s41, s21, 6
  s_add_u32 s40, s40, s41
  buffer_load_dwordx4 a[32:35], v40, s[48:51], s40 offen
  s_add_u32 s40, s40, 131072
  buffer_load_dwordx4 a[36:39], v40, s[48:51], s40 offen
  s_add_u32 s40, s40, 131072
  buffer_load_dwordx4 a[40:43], v40, s[48:51], s40 offen
  s_add_u32 s40, s40, 131072
  buffer_load_dwordx4 a[44:47], v40, s[48:51], s40 offen
  s_add_u32 s40, s40, 131072
  buffer_load_dwordx4 a[48:51], v40, s[48:51], s40 offen
  s_add_u32 s40, s40, 131072
  buffer_load_dwordx4 a[52:55], v40, s[48:51], s40 offen
  s_add_u32 s40, s40, 131072
  buffer_load_dwordx4 a[56:59], v40, s[48:51], s40 offen
  s_add_u32 s40, s40, 131072
  buffer_load_dwordx4 a[60:63], v40, s[48:51], s40 offen
  s_xor_b32 s40, s21, 2
  s_lshl_b32 s40, s40, 20
  s_lshl_b32 s41, s20, 8
  s_add_u32 s40, s40, s41
  s_lshl_b32 s41, s21, 6
  s_add_u32 s40, s40, s41
  buffer_load_dwordx4 v[192:195], v40, s[48:51], s40 offen
  s_add_u32 s40, s40, 131072
  buffer_load_dwordx4 v[196:199], v40, s[48:51], s40 offen
  s_add_u32 s40, s40, 131072
  buffer_load_dwordx4 v[200:203], v40, s[48:51], s40 offen
  s_add_u32 s40, s40, 131072
  buffer_load_dwordx4 v[204:207], v40, s[48:51], s40 offen
  s_add_u32 s40, s40, 131072
  buffer_load_dwordx4 v[208:211], v40, s[48:51], s40 offen
  s_add_u32 s40, s40, 131072
  buffer_load_dwordx4 v[212:215], v40, s[48:51], s40 offen
  s_add_u32 s40, s40, 131072
  buffer_load_dwordx4 v[216:219], v40, s[48:51], s40 offen
  s_add_u32 s40, s40, 131072
  buffer_load_dwordx4 v[220:223], v40, s[48:51], s40 offen
  v_lshlrev_b32 v1, 4, v0
  v_bfe_u32 v22, v0, 1, 1
  v_mov_b32 v2, 0x4444
  v_mov_b32 v23, 0xeeee
  v_cmp_eq_u32 vcc, 1, v22
  s_nop 1
  v_cndmask_b32 v2, v2, v23, vcc
  v_bfe_u32 v22, v0, 0, 4
  v_lshlrev_b32 v5, 4, v22
  v_bfe_u32 v22, v0, 4, 2
  v_lshl_add_u32 v5, v22, 2, v5
  v_add_u32 v6, 131072, v1
  s_lshl_b32 s40, s21, 11
  s_add_u32 s41, s40, 131072
  v_add_u32 v7, s41, v1
  s_xor_b32 s41, s40, 2048
  s_add_u32 s41, s41, 131072
  v_add_u32 v8, s41, v1
  s_xor_b32 s41, s40, 4096
  s_add_u32 s41, s41, 131072
  v_add_u32 v9, s41, v1
  s_xor_b32 s41, s40, 6144
  s_add_u32 s41, s41, 131072
  v_add_u32 v10, s41, v1
  s_lshl_b32 s40, s21, 15
  v_add_u32 v11, s40, v1
  s_lshl_b32 s40, s21, 9
  s_add_u32 s41, s40, 155648
  v_add_u32 v12, s41, v5
  s_add_u32 s41, s40, 157696
  v_bfe_u32 v22, v0, 2, 2
  v_lshlrev_b32 v13, 6, v22
  v_bfe_u32 v22, v0, 0, 1
  v_lshl_add_u32 v13, v22, 5, v13
  v_bfe_u32 v22, v0, 4, 2
  v_lshl_add_u32 v13, v22, 3, v13
  v_bfe_u32 v22, v0, 1, 1
  v_lshl_add_u32 v13, v22, 2, v13
  v_add_u32 v13, s41, v13
  v_bfe_u32 v22, v0, 5, 1
  v_lshlrev_b32 v14, 8, v22
  v_bfe_u32 v22, v0, 4, 1
  v_lshl_add_u32 v14, v22, 6, v14
  v_bfe_u32 v22, v0, 2, 2
  v_lshl_add_u32 v14, v22, 4, v14
  v_bfe_u32 v22, v0, 0, 1
  v_lshl_add_u32 v14, v22, 3, v14
  v_add_u32 v14, 155648, v14
  v_bfe_u32 v22, v0, 5, 1
  v_lshlrev_b32 v15, 9, v22
  v_bfe_u32 v22, v0, 4, 1
  v_lshl_add_u32 v15, v22, 8, v15
  v_bfe_u32 v22, v0, 3, 1
  v_lshl_add_u32 v15, v22, 7, v15
  v_bfe_u32 v22, v0, 2, 1
  v_lshl_add_u32 v15, v22, 5, v15
  v_bfe_u32 v22, v0, 0, 2
  v_lshl_add_u32 v15, v22, 3, v15
  v_add_u32 v15, 157696, v15
  s_lshr_b32 s40, s21, 1
  s_lshl_b32 s40, s40, 10
  s_and_b32 s41, s21, 1
  s_lshl_b32 s41, s41, 5
  s_add_u32 s40, s40, s41
  s_add_u32 s40, s40, 159744
  v_bfe_u32 v22, v0, 1, 2
  v_lshlrev_b32 v16, 6, v22
  v_bfe_u32 v22, v0, 0, 1
  v_lshl_add_u32 v16, v22, 4, v16
  v_bfe_u32 v22, v0, 5, 1
  v_lshl_add_u32 v16, v22, 8, v16
  v_bfe_u32 v22, v0, 4, 1
  v_lshl_add_u32 v16, v22, 3, v16
  v_add_u32 v16, s40, v16
  s_lshr_b32 s40, s20, 2
  s_lshl_b32 s40, s40, 10
  s_and_b32 s41, s20, 3
  s_lshl_b32 s42, s41, 8
  s_add_u32 s42, s42, s40
  v_bfe_u32 v22, v0, 4, 2
  v_lshlrev_b32 v3, 13, v22
  v_bfe_u32 v22, v0, 0, 4
  v_lshl_add_u32 v3, v22, 4, v3
  v_add_u32 v3, s42, v3
  s_lshl_b32 s42, s41, 6
  s_add_u32 s42, s42, s40
  v_bfe_u32 v22, v0, 2, 2
  v_lshlrev_b32 v4, 8, v22
  v_bfe_u32 v22, v0, 4, 1
  v_lshl_add_u32 v4, v22, 5, v4
  v_bfe_u32 v22, v0, 5, 1
  v_lshl_add_u32 v4, v22, 4, v4
  v_bfe_u32 v22, v0, 0, 2
  v_lshl_add_u32 v4, v22, 2, v4
  v_add_u32 v4, s42, v4
  v_bfe_u32 v22, v0, 2, 1
  v_lshlrev_b32 v72, 1, v22
  v_bfe_u32 v22, v0, 0, 2
  v_lshl_add_u32 v72, v22, 0, v72
  v_bfe_u32 v73, v0, 3, 1
  v_lshlrev_b32 v73, 4, v73
  v_mov_b32 v74, 0x3f80
  v_lshlrev_b32 v74, v73, v74
  v_bfe_u32 v75, v0, 1, 1
  v_cmp_eq_u32 vcc, 1, v75
  s_nop 1
  v_mov_b32 v76, 0
  v_cndmask_b32 v74, v74, v76, vcc
  v_cmp_eq_u32 vcc, 0, v72
  s_nop 1
  v_cndmask_b32 v18, v76, v74, vcc
  v_cmp_eq_u32 vcc, 1, v72
  s_nop 1
  v_cndmask_b32 v19, v76, v74, vcc
  v_cmp_eq_u32 vcc, 2, v72
  s_nop 1
  v_cndmask_b32 v20, v76, v74, vcc
  v_cmp_eq_u32 vcc, 3, v72
  s_nop 1
  v_cndmask_b32 v21, v76, v74, vcc
  v_add_u32 v17, 139264, v1
  s_cmp_eq_u32 s21, 0
  s_cbranch_scc0 CH_I_NOINIT
  v_mov_b32 v22, 0
  v_lshlrev_b32 v23, 2, v0
  s_lshl_b32 s44, s95, 6
  s_add_u32 s44, s44, 66125824
  s_mov_b64 exec, 0xffff
  buffer_store_dword v22, v23, s[8:11], s44 offen sc1
  s_mov_b64 exec, 1
  s_lshl_b32 s44, s94, 7
  s_add_u32 s44, s44, 66060288
  s_lshl_b32 s45, s20, 7
  s_add_u32 s45, s45, 66093056
  s_cmp_eq_u32 s92, 0
  s_cselect_b32 s44, s45, s44
  buffer_store_dword v22, v23, s[8:11], s44 offen sc1
  s_mov_b64 exec, -1
CH_I_NOINIT:
  s_lshl_b32 s40, s20, 13
  s_lshl_b32 s41, s21, 11
  s_add_u32 s40, s40, s41
  s_add_u32 s31, s40, 58720256
  s_add_u32 s40, s31, 262144
  v_mov_b32 v72, -1
  v_mov_b32 v73, -1
  v_mov_b32 v74, -1
  v_mov_b32 v75, -1
  buffer_store_dwordx4 v[72:75], v1, s[8:11], s31 offen offset:0
  buffer_store_dwordx4 v[72:75], v1, s[8:11], s40 offen offset:0
  buffer_store_dwordx4 v[72:75], v1, s[8:11], s31 offen offset:1024
  buffer_store_dwordx4 v[72:75], v1, s[8:11], s40 offen offset:1024
  s_cmp_eq_u32 s21, 0
  s_cbranch_scc0 CH_NORING
  s_lshl_b32 s41, s20, 10
  s_cmp_lt_u32 s20, 24
  s_cbranch_scc0 CH_NORING2
  s_add_u32 s40, s41, 59768832
  buffer_store_dwordx4 v[72:75], v1, s[8:11], s40 offen
  s_branch CH_NORING
CH_NORING2:
CH_NORING:
  s_waitcnt vmcnt(48)
  s_xor_b32 s40, s21, 3
  s_lshl_b32 s40, s40, 20
  s_lshl_b32 s41, s20, 8
  s_add_u32 s40, s40, s41
  s_lshl_b32 s41, s21, 6
  s_add_u32 s40, s40, s41
  buffer_load_dwordx4 v[224:227], v40, s[48:51], s40 offen
  s_add_u32 s40, s40, 131072
  buffer_load_dwordx4 v[228:231], v40, s[48:51], s40 offen
  s_add_u32 s40, s40, 131072
  buffer_load_dwordx4 v[232:235], v40, s[48:51], s40 offen
  s_add_u32 s40, s40, 131072
  buffer_load_dwordx4 v[236:239], v40, s[48:51], s40 offen
  s_add_u32 s40, s40, 131072
  buffer_load_dwordx4 v[240:243], v40, s[48:51], s40 offen
  s_add_u32 s40, s40, 131072
  buffer_load_dwordx4 v[244:247], v40, s[48:51], s40 offen
  s_add_u32 s40, s40, 131072
  buffer_load_dwordx4 v[248:251], v40, s[48:51], s40 offen
  s_add_u32 s40, s40, 131072
  buffer_load_dwordx4 v[252:255], v40, s[48:51], s40 offen
  ds_write_b128 v50, a[64:67] offset:0
  ds_write_b128 v50, a[68:71] offset:2048
  ds_write_b128 v50, a[72:75] offset:4096
  ds_write_b128 v50, a[76:79] offset:6144
  ds_write_b128 v50, a[80:83] offset:128
  ds_write_b128 v50, a[84:87] offset:2176
  ds_write_b128 v50, a[88:91] offset:4224
  ds_write_b128 v50, a[92:95] offset:6272
  s_waitcnt lgkmcnt(0)
  ds_read_b64_tr_b16 a[64:65], v51 offset:0
  ds_read_b64_tr_b16 a[66:67], v51 offset:1024
  ds_read_b64_tr_b16 a[68:69], v51 offset:4096
  ds_read_b64_tr_b16 a[70:71], v51 offset:5120
  ds_read_b64_tr_b16 a[72:73], v51 offset:256
  ds_read_b64_tr_b16 a[74:75], v51 offset:1280
  ds_read_b64_tr_b16 a[76:77], v51 offset:4352
  ds_read_b64_tr_b16 a[78:79], v51 offset:5376
  ds_read_b64_tr_b16 a[80:81], v51 offset:512
  ds_read_b64_tr_b16 a[82:83], v51 offset:1536
  ds_read_b64_tr_b16 a[84:85], v51 offset:4608
  ds_read_b64_tr_b16 a[86:87], v51 offset:5632
  ds_read_b64_tr_b16 a[88:89], v51 offset:768
  ds_read_b64_tr_b16 a[90:91], v51 offset:1792
  ds_read_b64_tr_b16 a[92:93], v51 offset:4864
  ds_read_b64_tr_b16 a[94:95], v51 offset:5888
  s_waitcnt lgkmcnt(0)
  s_waitcnt vmcnt(48)
  s_xor_b32 s40, s21, 0
  s_lshl_b32 s40, s40, 20
  s_lshl_b32 s41, s20, 8
  s_add_u32 s40, s40, s41
  s_lshl_b32 s41, s21, 6
  s_add_u32 s40, s40, s41
  buffer_load_dwordx4 a[128:131], v40, s[52:55], s40 offen
  s_add_u32 s40, s40, 131072
  buffer_load_dwordx4 a[132:135], v40, s[52:55], s40 offen
  s_add_u32 s40, s40, 131072
  buffer_load_dwordx4 a[136:139], v40, s[52:55], s40 offen
  s_add_u32 s40, s40, 131072
  buffer_load_dwordx4 a[140:143], v40, s[52:55], s40 offen
  s_add_u32 s40, s40, 131072
  buffer_load_dwordx4 a[144:147], v40, s[52:55], s40 offen
  s_add_u32 s40, s40, 131072
  buffer_load_dwordx4 a[148:151], v40, s[52:55], s40 offen
  s_add_u32 s40, s40, 131072
  buffer_load_dwordx4 a[152:155], v40, s[52:55], s40 offen
  s_add_u32 s40, s40, 131072
  buffer_load_dwordx4 a[156:159], v40, s[52:55], s40 offen
  ds_write_b128 v50, a[96:99] offset:0
  ds_write_b128 v50, a[100:103] offset:2048
  ds_write_b128 v50, a[104:107] offset:4096
  ds_write_b128 v50, a[108:111] offset:6144
  ds_write_b128 v50, a[112:115] offset:128
  ds_write_b128 v50, a[116:119] offset:2176
  ds_write_b128 v50, a[120:123] offset:4224
  ds_write_b128 v50, a[124:127] offset:6272
  s_waitcnt lgkmcnt(0)
  ds_read_b64_tr_b16 a[96:97], v51 offset:0
  ds_read_b64_tr_b16 a[98:99], v51 offset:1024
  ds_read_b64_tr_b16 a[100:101], v51 offset:4096
  ds_read_b64_tr_b16 a[102:103], v51 offset:5120
  ds_read_b64_tr_b16 a[104:105], v51 offset:256
  ds_read_b64_tr_b16 a[106:107], v51 offset:1280
  ds_read_b64_tr_b16 a[108:109], v51 offset:4352
  ds_read_b64_tr_b16 a[110:111], v51 offset:5376
  ds_read_b64_tr_b16 a[112:113], v51 offset:512
  ds_read_b64_tr_b16 a[114:115], v51 offset:1536
  ds_read_b64_tr_b16 a[116:117], v51 offset:4608
  ds_read_b64_tr_b16 a[118:119], v51 offset:5632
  ds_read_b64_tr_b16 a[120:121], v51 offset:768
  ds_read_b64_tr_b16 a[122:123], v51 offset:1792
  ds_read_b64_tr_b16 a[124:125], v51 offset:4864
  ds_read_b64_tr_b16 a[126:127], v51 offset:5888
  s_waitcnt lgkmcnt(0)
  s_waitcnt vmcnt(48)
  s_xor_b32 s40, s21, 1
  s_lshl_b32 s40, s40, 20
  s_lshl_b32 s41, s20, 8
  s_add_u32 s40, s40, s41
  s_lshl_b32 s41, s21, 6
  s_add_u32 s40, s40, s41
  buffer_load_dwordx4 a[160:163], v40, s[52:55], s40 offen
  s_add_u32 s40, s40, 131072
  buffer_load_dwordx4 a[164:167], v40, s[52:55], s40 offen
  s_add_u32 s40, s40, 131072
  buffer_load_dwordx4 a[168:171], v40, s[52:55], s40 offen
  s_add_u32 s40, s40, 131072
  buffer_load_dwordx4 a[172:175], v40, s[52:55], s40 offen
  s_add_u32 s40, s40, 131072
  buffer_load_dwordx4 a[176:179], v40, s[52:55], s40 offen
  s_add_u32 s40, s40, 131072
  buffer_load_dwordx4 a[180:183], v40, s[52:55], s40 offen
  s_add_u32 s40, s40, 131072
  buffer_load_dwordx4 a[184:187], v40, s[52:55], s40 offen
  s_add_u32 s40, s40, 131072
  buffer_load_dwordx4 a[188:191], v40, s[52:55], s40 offen
  ds_write_b128 v50, v[128:131] offset:0
  ds_write_b128 v50, v[132:135] offset:2048
  ds_write_b128 v50, v[136:139] offset:4096
  ds_write_b128 v50, v[140:143] offset:6144
  ds_write_b128 v50, v[144:147] offset:128
  ds_write_b128 v50, v[148:151] offset:2176
  ds_write_b128 v50, v[152:155] offset:4224
  ds_write_b128 v50, v[156:159] offset:6272
  s_waitcnt lgkmcnt(0)
  ds_read_b64_tr_b16 v[96:97], v51 offset:0
  ds_read_b64_tr_b16 v[98:99], v51 offset:1024
  ds_read_b64_tr_b16 v[100:101], v51 offset:4096
  ds_read_b64_tr_b16 v[102:103], v51 offset:5120
  ds_read_b64_tr_b16 v[104:105], v51 offset:256
  ds_read_b64_tr_b16 v[106:107], v51 offset:1280
  ds_read_b64_tr_b16 v[108:109], v51 offset:4352
  ds_read_b64_tr_b16 v[110:111], v51 offset:5376
  ds_read_b64_tr_b16 v[112:113], v51 offset:512
  ds_read_b64_tr_b16 v[114:115], v51 offset:1536
  ds_read_b64_tr_b16 v[116:117], v51 offset:4608
  ds_read_b64_tr_b16 v[118:119], v51 offset:5632
  ds_read_b64_tr_b16 v[120:121], v51 offset:768
  ds_read_b64_tr_b16 v[122:123], v51 offset:1792
  ds_read_b64_tr_b16 v[124:125], v51 offset:4864
  ds_read_b64_tr_b16 v[126:127], v51 offset:5888
  s_waitcnt lgkmcnt(0)
  ds_write_b128 v11, v[96:99] offset:0
  ds_write_b128 v11, v[100:103] offset:1024
  ds_write_b128 v11, v[104:107] offset:4096
  ds_write_b128 v11, v[108:111] offset:5120
  ds_write_b128 v11, v[112:115] offset:8192
  ds_write_b128 v11, v[116:119] offset:9216
  ds_write_b128 v11, v[120:123] offset:12288
  ds_write_b128 v11, v[124:127] offset:13312
  s_waitcnt lgkmcnt(0)
  s_waitcnt vmcnt(48)
  s_xor_b32 s40, s21, 2
  s_lshl_b32 s40, s40, 20
  s_lshl_b32 s41, s20, 8
  s_add_u32 s40, s40, s41
  s_lshl_b32 s41, s21, 6
  s_add_u32 s40, s40, s41
  buffer_load_dwordx4 a[192:195], v40, s[52:55], s40 offen
  s_add_u32 s40, s40, 131072
  buffer_load_dwordx4 a[196:199], v40, s[52:55], s40 offen
  s_add_u32 s40, s40, 131072
  buffer_load_dwordx4 a[200:203], v40, s[52:55], s40 offen
  s_add_u32 s40, s40, 131072
  buffer_load_dwordx4 a[204:207], v40, s[52:55], s40 offen
  s_add_u32 s40, s40, 131072
  buffer_load_dwordx4 a[208:211], v40, s[52:55], s40 offen
  s_add_u32 s40, s40, 131072
  buffer_load_dwordx4 a[212:215], v40, s[52:55], s40 offen
  s_add_u32 s40, s40, 131072
  buffer_load_dwordx4 a[216:219], v40, s[52:55], s40 offen
  s_add_u32 s40, s40, 131072
  buffer_load_dwordx4 a[220:223], v40, s[52:55], s40 offen
  ds_write_b128 v50, v[160:163] offset:0
  ds_write_b128 v50, v[164:167] offset:2048
  ds_write_b128 v50, v[168:171] offset:4096
  ds_write_b128 v50, v[172:175] offset:6144
  ds_write_b128 v50, v[176:179] offset:128
  ds_write_b128 v50, v[180:183] offset:2176
  ds_write_b128 v50, v[184:187] offset:4224
  ds_write_b128 v50, v[188:191] offset:6272
  s_waitcnt lgkmcnt(0)
  ds_read_b64_tr_b16 v[96:97], v51 offset:0
  ds_read_b64_tr_b16 v[98:99], v51 offset:1024
  ds_read_b64_tr_b16 v[100:101], v51 offset:4096
  ds_read_b64_tr_b16 v[102:103], v51 offset:5120
  ds_read_b64_tr_b16 v[104:105], v51 offset:256
  ds_read_b64_tr_b16 v[106:107], v51 offset:1280
  ds_read_b64_tr_b16 v[108:109], v51 offset:4352
  ds_read_b64_tr_b16 v[110:111], v51 offset:5376
  ds_read_b64_tr_b16 v[112:113], v51 offset:512
  ds_read_b64_tr_b16 v[114:115], v51 offset:1536
  ds_read_b64_tr_b16 v[116:117], v51 offset:4608
  ds_read_b64_tr_b16 v[118:119], v51 offset:5632
  ds_read_b64_tr_b16 v[120:121], v51 offset:768
  ds_read_b64_tr_b16 v[122:123], v51 offset:1792
  ds_read_b64_tr_b16 v[124:125], v51 offset:4864
  ds_read_b64_tr_b16 v[126:127], v51 offset:5888
  s_waitcnt lgkmcnt(0)
  ds_write_b128 v11, v[96:99] offset:2048
  ds_write_b128 v11, v[100:103] offset:3072
  ds_write_b128 v11, v[104:107] offset:6144
  ds_write_b128 v11, v[108:111] offset:7168
  ds_write_b128 v11, v[112:115] offset:10240
  ds_write_b128 v11, v[116:119] offset:11264
  ds_write_b128 v11, v[120:123] offset:14336
  ds_write_b128 v11, v[124:127] offset:15360
  s_waitcnt lgkmcnt(0)
  s_waitcnt vmcnt(48)
  s_xor_b32 s40, s21, 3
  s_lshl_b32 s40, s40, 20
  s_lshl_b32 s41, s20, 8
  s_add_u32 s40, s40, s41
  s_lshl_b32 s41, s21, 6
  s_add_u32 s40, s40, s41
  buffer_load_dwordx4 a[224:227], v40, s[52:55], s40 offen
  s_add_u32 s40, s40, 131072
  buffer_load_dwordx4 a[228:231], v40, s[52:55], s40 offen
  s_add_u32 s40, s40, 131072
  buffer_load_dwordx4 a[232:235], v40, s[52:55], s40 offen
  s_add_u32 s40, s40, 131072
  buffer_load_dwordx4 a[236:239], v40, s[52:55], s40 offen
  s_add_u32 s40, s40, 131072
  buffer_load_dwordx4 a[240:243], v40, s[52:55], s40 offen
  s_add_u32 s40, s40, 131072
  buffer_load_dwordx4 a[244:247], v40, s[52:55], s40 offen
  s_add_u32 s40, s40, 131072
  buffer_load_dwordx4 a[248:251], v40, s[52:55], s40 offen
  s_add_u32 s40, s40, 131072
  buffer_load_dwordx4 a[252:255], v40, s[52:55], s40 offen
  ds_write_b128 v42, a[0:3] offset:0
  ds_write_b128 v43, a[4:7] offset:0
  ds_write_b128 v44, a[8:11] offset:0
  ds_write_b128 v45, a[12:15] offset:0
  ds_write_b128 v42, a[16:19] offset:4096
  ds_write_b128 v43, a[20:23] offset:4096
  ds_write_b128 v44, a[24:27] offset:4096
  ds_write_b128 v45, a[28:31] offset:4096
  s_waitcnt lgkmcnt(0)
  ds_read_b64_tr_b16 a[0:1], v46 offset:0
  ds_read_b64_tr_b16 a[2:3], v48 offset:512
  ds_read_b64_tr_b16 a[4:5], v46 offset:2048
  ds_read_b64_tr_b16 a[6:7], v48 offset:2560
  ds_read_b64_tr_b16 a[8:9], v46 offset:4096
  ds_read_b64_tr_b16 a[10:11], v48 offset:4608
  ds_read_b64_tr_b16 a[12:13], v46 offset:6144
  ds_read_b64_tr_b16 a[14:15], v48 offset:6656
  ds_read_b64_tr_b16 v[96:97], v47 offset:256
  ds_read_b64_tr_b16 v[98:99], v49 offset:768
  ds_read_b64_tr_b16 v[100:101], v47 offset:2304
  ds_read_b64_tr_b16 v[102:103], v49 offset:2816
  ds_read_b64_tr_b16 v[104:105], v47 offset:4352
  ds_read_b64_tr_b16 v[106:107], v49 offset:4864
  ds_read_b64_tr_b16 v[108:109], v47 offset:6400
  ds_read_b64_tr_b16 v[110:111], v49 offset:6912
  s_waitcnt lgkmcnt(0)
  ds_write_b128 v11, v[96:99] offset:16384
  ds_write_b128 v11, v[100:103] offset:17408
  ds_write_b128 v11, v[104:107] offset:18432
  ds_write_b128 v11, v[108:111] offset:19456
  s_waitcnt lgkmcnt(0)
  s_waitcnt vmcnt(48)
  s_xor_b32 s40, s21, 0
  s_lshl_b32 s40, s40, 20
  s_lshl_b32 s41, s20, 8
  s_add_u32 s40, s40, s41
  s_lshl_b32 s41, s21, 6
  s_add_u32 s40, s40, s41
  buffer_load_dwordx4 v[128:131], v40, s[56:59], s40 offen
  s_add_u32 s40, s40, 131072
  buffer_load_dwordx4 v[132:135], v40, s[56:59], s40 offen
  s_add_u32 s40, s40, 131072
  buffer_load_dwordx4 v[136:139], v40, s[56:59], s40 offen
  s_add_u32 s40, s40, 131072
  buffer_load_dwordx4 v[140:143], v40, s[56:59], s40 offen
  s_add_u32 s40, s40, 131072
  buffer_load_dwordx4 v[144:147], v40, s[56:59], s40 offen
  s_add_u32 s40, s40, 131072
  buffer_load_dwordx4 v[148:151], v40, s[56:59], s40 offen
  s_add_u32 s40, s40, 131072
  buffer_load_dwordx4 v[152:155], v40, s[56:59], s40 offen
  s_add_u32 s40, s40, 131072
  buffer_load_dwordx4 v[156:159], v40, s[56:59], s40 offen
  ds_write_b128 v42, a[32:35] offset:0
  ds_write_b128 v43, a[36:39] offset:0
  ds_write_b128 v44, a[40:43] offset:0
  ds_write_b128 v45, a[44:47] offset:0
  ds_write_b128 v42, a[48:51] offset:4096
  ds_write_b128 v43, a[52:55] offset:4096
  ds_write_b128 v44, a[56:59] offset:4096
  ds_write_b128 v45, a[60:63] offset:4096
  s_waitcnt lgkmcnt(0)
  ds_read_b64_tr_b16 a[16:17], v46 offset:0
  ds_read_b64_tr_b16 a[18:19], v48 offset:512
  ds_read_b64_tr_b16 a[20:21], v46 offset:2048
  ds_read_b64_tr_b16 a[22:23], v48 offset:2560
  ds_read_b64_tr_b16 a[24:25], v46 offset:4096
  ds_read_b64_tr_b16 a[26:27], v48 offset:4608
  ds_read_b64_tr_b16 a[28:29], v46 offset:6144
  ds_read_b64_tr_b16 a[30:31], v48 offset:6656
  ds_read_b64_tr_b16 v[96:97], v47 offset:256
  ds_read_b64_tr_b16 v[98:99], v49 offset:768
  ds_read_b64_tr_b16 v[100:101], v47 offset:2304
  ds_read_b64_tr_b16 v[102:103], v49 offset:2816
  ds_read_b64_tr_b16 v[104:105], v47 offset:4352
  ds_read_b64_tr_b16 v[106:107], v49 offset:4864
  ds_read_b64_tr_b16 v[108:109], v47 offset:6400
  ds_read_b64_tr_b16 v[110:111], v49 offset:6912
  s_waitcnt lgkmcnt(0)
  ds_write_b128 v11, v[96:99] offset:20480
  ds_write_b128 v11, v[100:103] offset:21504
  ds_write_b128 v11, v[104:107] offset:22528
  ds_write_b128 v11, v[108:111] offset:23552
  s_waitcnt lgkmcnt(0)
  s_waitcnt vmcnt(48)
  s_xor_b32 s40, s21, 1
  s_lshl_b32 s40, s40, 20
  s_lshl_b32 s41, s20, 8
  s_add_u32 s40, s40, s41
  s_lshl_b32 s41, s21, 6
  s_add_u32 s40, s40, s41
  buffer_load_dwordx4 v[160:163], v40, s[56:59], s40 offen
  s_add_u32 s40, s40, 131072
  buffer_load_dwordx4 v[164:167], v40, s[56:59], s40 offen
  s_add_u32 s40, s40, 131072
  buffer_load_dwordx4 v[168:171], v40, s[56:59], s40 offen
  s_add_u32 s40, s40, 131072
  buffer_load_dwordx4 v[172:175], v40, s[56:59], s40 offen
  s_add_u32 s40, s40, 131072
  buffer_load_dwordx4 v[176:179], v40, s[56:59], s40 offen
  s_add_u32 s40, s40, 131072
  buffer_load_dwordx4 v[180:183], v40, s[56:59], s40 offen
  s_add_u32 s40, s40, 131072
  buffer_load_dwordx4 v[184:187], v40, s[56:59], s40 offen
  s_add_u32 s40, s40, 131072
  buffer_load_dwordx4 v[188:191], v40, s[56:59], s40 offen
  ds_write_b128 v42, v[192:195] offset:0
  ds_write_b128 v43, v[196:199] offset:0
  ds_write_b128 v44, v[200:203] offset:0
  ds_write_b128 v45, v[204:207] offset:0
  ds_write_b128 v42, v[208:211] offset:4096
  ds_write_b128 v43, v[212:215] offset:4096
  ds_write_b128 v44, v[216:219] offset:4096
  ds_write_b128 v45, v[220:223] offset:4096
  s_waitcnt lgkmcnt(0)
  ds_read_b64_tr_b16 a[32:33], v46 offset:0
  ds_read_b64_tr_b16 a[34:35], v48 offset:512
  ds_read_b64_tr_b16 a[36:37], v46 offset:2048
  ds_read_b64_tr_b16 a[38:39], v48 offset:2560
  ds_read_b64_tr_b16 a[40:41], v46 offset:4096
  ds_read_b64_tr_b16 a[42:43], v48 offset:4608
  ds_read_b64_tr_b16 a[44:45], v46 offset:6144
  ds_read_b64_tr_b16 a[46:47], v48 offset:6656
  ds_read_b64_tr_b16 v[96:97], v47 offset:256
  ds_read_b64_tr_b16 v[98:99], v49 offset:768
  ds_read_b64_tr_b16 v[100:101], v47 offset:2304
  ds_read_b64_tr_b16 v[102:103], v49 offset:2816
  ds_read_b64_tr_b16 v[104:105], v47 offset:4352
  ds_read_b64_tr_b16 v[106:107], v49 offset:4864
  ds_read_b64_tr_b16 v[108:109], v47 offset:6400
  ds_read_b64_tr_b16 v[110:111], v49 offset:6912
  s_waitcnt lgkmcnt(0)
  ds_write_b128 v11, v[96:99] offset:24576
  ds_write_b128 v11, v[100:103] offset:25600
  ds_write_b128 v11, v[104:107] offset:26624
  ds_write_b128 v11, v[108:111] offset:27648
  s_waitcnt lgkmcnt(0)
  s_waitcnt vmcnt(48)
  s_xor_b32 s40, s21, 2
  s_lshl_b32 s40, s40, 20
  s_lshl_b32 s41, s20, 8
  s_add_u32 s40, s40, s41
  s_lshl_b32 s41, s21, 6
  s_add_u32 s40, s40, s41
  buffer_load_dwordx4 v[192:195], v40, s[56:59], s40 offen
  s_add_u32 s40, s40, 131072
  buffer_load_dwordx4 v[196:199], v40, s[56:59], s40 offen
  s_add_u32 s40, s40, 131072
  buffer_load_dwordx4 v[200:203], v40, s[56:59], s40 offen
  s_add_u32 s40, s40, 131072
  buffer_load_dwordx4 v[204:207], v40, s[56:59], s40 offen
  s_add_u32 s40, s40, 131072
  buffer_load_dwordx4 v[208:211], v40, s[56:59], s40 offen
  s_add_u32 s40, s40, 131072
  buffer_load_dwordx4 v[212:215], v40, s[56:59], s40 offen
  s_add_u32 s40, s40, 131072
  buffer_load_dwordx4 v[216:219], v40, s[56:59], s40 offen
  s_add_u32 s40, s40, 131072
  buffer_load_dwordx4 v[220:223], v40, s[56:59], s40 offen
  ds_write_b128 v42, v[224:227] offset:0
  ds_write_b128 v43, v[228:231] offset:0
  ds_write_b128 v44, v[232:235] offset:0
  ds_write_b128 v45, v[236:239] offset:0
  ds_write_b128 v42, v[240:243] offset:4096
  ds_write_b128 v43, v[244:247] offset:4096
  ds_write_b128 v44, v[248:251] offset:4096
  ds_write_b128 v45, v[252:255] offset:4096
  s_waitcnt lgkmcnt(0)
  ds_read_b64_tr_b16 a[48:49], v46 offset:0
  ds_read_b64_tr_b16 a[50:51], v48 offset:512
  ds_read_b64_tr_b16 a[52:53], v46 offset:2048
  ds_read_b64_tr_b16 a[54:55], v48 offset:2560
  ds_read_b64_tr_b16 a[56:57], v46 offset:4096
  ds_read_b64_tr_b16 a[58:59], v48 offset:4608
  ds_read_b64_tr_b16 a[60:61], v46 offset:6144
  ds_read_b64_tr_b16 a[62:63], v48 offset:6656
  ds_read_b64_tr_b16 v[96:97], v47 offset:256
  ds_read_b64_tr_b16 v[98:99], v49 offset:768
  ds_read_b64_tr_b16 v[100:101], v47 offset:2304
  ds_read_b64_tr_b16 v[102:103], v49 offset:2816
  ds_read_b64_tr_b16 v[104:105], v47 offset:4352
  ds_read_b64_tr_b16 v[106:107], v49 offset:4864
  ds_read_b64_tr_b16 v[108:109], v47 offset:6400
  ds_read_b64_tr_b16 v[110:111], v49 offset:6912
  s_waitcnt lgkmcnt(0)
  ds_write_b128 v11, v[96:99] offset:28672
  ds_write_b128 v11, v[100:103] offset:29696
  ds_write_b128 v11, v[104:107] offset:30720
  ds_write_b128 v11, v[108:111] offset:31744
  s_waitcnt lgkmcnt(0)
  s_barrier
  s_cmp_eq_u32 s21, 0
  s_cbranch_scc0 CH_S_NOSIG
  s_mov_b64 exec, 1
  v_mov_b32 v23, 1
  v_mov_b32 v22, 32
  buffer_atomic_add v23, v22, s[16:19], 0 offen
  v_mov_b32 v22, 36
  buffer_atomic_add v23, v22, s[16:19], 0 offen
  s_mov_b64 exec, -1
CH_S_NOSIG:
  s_waitcnt vmcnt(48)
  s_xor_b32 s40, s21, 3
  s_lshl_b32 s40, s40, 20
  s_lshl_b32 s41, s20, 8
  s_add_u32 s40, s40, s41
  s_lshl_b32 s41, s21, 6
  s_add_u32 s40, s40, s41
  buffer_load_dwordx4 v[224:227], v40, s[56:59], s40 offen
  s_add_u32 s40, s40, 131072
  buffer_load_dwordx4 v[228:231], v40, s[56:59], s40 offen
  s_add_u32 s40, s40, 131072
  buffer_load_dwordx4 v[232:235], v40, s[56:59], s40 offen
  s_add_u32 s40, s40, 131072
  buffer_load_dwordx4 v[236:239], v40, s[56:59], s40 offen
  s_add_u32 s40, s40, 131072
  buffer_load_dwordx4 v[240:243], v40, s[56:59], s40 offen
  s_add_u32 s40, s40, 131072
  buffer_load_dwordx4 v[244:247], v40, s[56:59], s40 offen
  s_add_u32 s40, s40, 131072
  buffer_load_dwordx4 v[248:251], v40, s[56:59], s40 offen
  s_add_u32 s40, s40, 131072
  buffer_load_dwordx4 v[252:255], v40, s[56:59], s40 offen
  ds_write_b128 v42, a[128:131] offset:0
  ds_write_b128 v43, a[132:135] offset:0
  ds_write_b128 v44, a[136:139] offset:0
  ds_write_b128 v45, a[140:143] offset:0
  ds_write_b128 v42, a[144:147] offset:4096
  ds_write_b128 v43, a[148:151] offset:4096
  ds_write_b128 v44, a[152:155] offset:4096
  ds_write_b128 v45, a[156:159] offset:4096
  s_waitcnt lgkmcnt(0)
  ds_read_b64_tr_b16 a[128:129], v46 offset:0
  ds_read_b64_tr_b16 a[130:131], v48 offset:512
  ds_read_b64_tr_b16 a[132:133], v46 offset:2048
  ds_read_b64_tr_b16 a[134:135], v48 offset:2560
  ds_read_b64_tr_b16 a[136:137], v46 offset:4096
  ds_read_b64_tr_b16 a[138:139], v48 offset:4608
  ds_read_b64_tr_b16 a[140:141], v46 offset:6144
  ds_read_b64_tr_b16 a[142:143], v48 offset:6656
  ds_read_b64_tr_b16 a[144:145], v47 offset:256
  ds_read_b64_tr_b16 a[146:147], v49 offset:768
  ds_read_b64_tr_b16 a[148:149], v47 offset:2304
  ds_read_b64_tr_b16 a[150:151], v49 offset:2816
  ds_read_b64_tr_b16 a[152:153], v47 offset:4352
  ds_read_b64_tr_b16 a[154:155], v49 offset:4864
  ds_read_b64_tr_b16 a[156:157], v47 offset:6400
  ds_read_b64_tr_b16 a[158:159], v49 offset:6912
  s_waitcnt lgkmcnt(0)
  s_waitcnt vmcnt(48)
  ds_write_b128 v42, a[160:163] offset:0
  ds_write_b128 v43, a[164:167] offset:0
  ds_write_b128 v44, a[168:171] offset:0
  ds_write_b128 v45, a[172:175] offset:0
  ds_write_b128 v42, a[176:179] offset:4096
  ds_write_b128 v43, a[180:183] offset:4096
  ds_write_b128 v44, a[184:187] offset:4096
  ds_write_b128 v45, a[188:191] offset:4096
  s_waitcnt lgkmcnt(0)
  ds_read_b64_tr_b16 a[160:161], v46 offset:0
  ds_read_b64_tr_b16 a[162:163], v48 offset:512
  ds_read_b64_tr_b16 a[164:165], v46 offset:2048
  ds_read_b64_tr_b16 a[166:167], v48 offset:2560
  ds_read_b64_tr_b16 a[168:169], v46 offset:4096
  ds_read_b64_tr_b16 a[170:171], v48 offset:4608
  ds_read_b64_tr_b16 a[172:173], v46 offset:6144
  ds_read_b64_tr_b16 a[174:175], v48 offset:6656
  ds_read_b64_tr_b16 a[176:177], v47 offset:256
  ds_read_b64_tr_b16 a[178:179], v49 offset:768
  ds_read_b64_tr_b16 a[180:181], v47 offset:2304
  ds_read_b64_tr_b16 a[182:183], v49 offset:2816
  ds_read_b64_tr_b16 a[184:185], v47 offset:4352
  ds_read_b64_tr_b16 a[186:187], v49 offset:4864
  ds_read_b64_tr_b16 a[188:189], v47 offset:6400
  ds_read_b64_tr_b16 a[190:191], v49 offset:6912
  s_waitcnt lgkmcnt(0)
  s_waitcnt vmcnt(40)
  ds_write_b128 v42, a[192:195] offset:0
  ds_write_b128 v43, a[196:199] offset:0
  ds_write_b128 v44, a[200:203] offset:0
  ds_write_b128 v45, a[204:207] offset:0
  ds_write_b128 v42, a[208:211] offset:4096
  ds_write_b128 v43, a[212:215] offset:4096
  ds_write_b128 v44, a[216:219] offset:4096
  ds_write_b128 v45, a[220:223] offset:4096
  s_waitcnt lgkmcnt(0)
  ds_read_b64_tr_b16 a[192:193], v46 offset:0
  ds_read_b64_tr_b16 a[194:195], v48 offset:512
  ds_read_b64_tr_b16 a[196:197], v46 offset:2048
  ds_read_b64_tr_b16 a[198:199], v48 offset:2560
  ds_read_b64_tr_b16 a[200:201], v46 offset:4096
  ds_read_b64_tr_b16 a[202:203], v48 offset:4608
  ds_read_b64_tr_b16 a[204:205], v46 offset:6144
  ds_read_b64_tr_b16 a[206:207], v48 offset:6656
  ds_read_b64_tr_b16 a[208:209], v47 offset:256
  ds_read_b64_tr_b16 a[210:211], v49 offset:768
  ds_read_b64_tr_b16 a[212:213], v47 offset:2304
  ds_read_b64_tr_b16 a[214:215], v49 offset:2816
  ds_read_b64_tr_b16 a[216:217], v47 offset:4352
  ds_read_b64_tr_b16 a[218:219], v49 offset:4864
  ds_read_b64_tr_b16 a[220:221], v47 offset:6400
  ds_read_b64_tr_b16 a[222:223], v49 offset:6912
  s_waitcnt lgkmcnt(0)
  s_waitcnt vmcnt(32)
  ds_write_b128 v42, a[224:227] offset:0
  ds_write_b128 v43, a[228:231] offset:0
  ds_write_b128 v44, a[232:235] offset:0
  ds_write_b128 v45, a[236:239] offset:0
  ds_write_b128 v42, a[240:243] offset:4096
  ds_write_b128 v43, a[244:247] offset:4096
  ds_write_b128 v44, a[248:251] offset:4096
  ds_write_b128 v45, a[252:255] offset:4096
  s_waitcnt lgkmcnt(0)
  ds_read_b64_tr_b16 a[224:225], v46 offset:0
  ds_read_b64_tr_b16 a[226:227], v48 offset:512
  ds_read_b64_tr_b16 a[228:229], v46 offset:2048
  ds_read_b64_tr_b16 a[230:231], v48 offset:2560
  ds_read_b64_tr_b16 a[232:233], v46 offset:4096
  ds_read_b64_tr_b16 a[234:235], v48 offset:4608
  ds_read_b64_tr_b16 a[236:237], v46 offset:6144
  ds_read_b64_tr_b16 a[238:239], v48 offset:6656
  ds_read_b64_tr_b16 a[240:241], v47 offset:256
  ds_read_b64_tr_b16 a[242:243], v49 offset:768
  ds_read_b64_tr_b16 a[244:245], v47 offset:2304
  ds_read_b64_tr_b16 a[246:247], v49 offset:2816
  ds_read_b64_tr_b16 a[248:249], v47 offset:4352
  ds_read_b64_tr_b16 a[250:251], v49 offset:4864
  ds_read_b64_tr_b16 a[252:253], v47 offset:6400
  ds_read_b64_tr_b16 a[254:255], v49 offset:6912
  s_waitcnt lgkmcnt(0)
  s_waitcnt vmcnt(24)
  ds_write_b128 v42, v[128:131] offset:0
  ds_write_b128 v43, v[132:135] offset:0
  ds_write_b128 v44, v[136:139] offset:0
  ds_write_b128 v45, v[140:143] offset:0
  ds_write_b128 v42, v[144:147] offset:4096
  ds_write_b128 v43, v[148:151] offset:4096
  ds_write_b128 v44, v[152:155] offset:4096
  ds_write_b128 v45, v[156:159] offset:4096
  s_waitcnt lgkmcnt(0)
  ds_read_b64_tr_b16 v[128:129], v46 offset:0
  ds_read_b64_tr_b16 v[130:131], v48 offset:512
  ds_read_b64_tr_b16 v[132:133], v46 offset:2048
  ds_read_b64_tr_b16 v[134:135], v48 offset:2560
  ds_read_b64_tr_b16 v[136:137], v46 offset:4096
  ds_read_b64_tr_b16 v[138:139], v48 offset:4608
  ds_read_b64_tr_b16 v[140:141], v46 offset:6144
  ds_read_b64_tr_b16 v[142:143], v48 offset:6656
  ds_read_b64_tr_b16 v[144:145], v47 offset:256
  ds_read_b64_tr_b16 v[146:147], v49 offset:768
  ds_read_b64_tr_b16 v[148:149], v47 offset:2304
  ds_read_b64_tr_b16 v[150:151], v49 offset:2816
  ds_read_b64_tr_b16 v[152:153], v47 offset:4352
  ds_read_b64_tr_b16 v[154:155], v49 offset:4864
  ds_read_b64_tr_b16 v[156:157], v47 offset:6400
  ds_read_b64_tr_b16 v[158:159], v49 offset:6912
  s_waitcnt lgkmcnt(0)
  s_waitcnt vmcnt(16)
  ds_write_b128 v42, v[160:163] offset:0
  ds_write_b128 v43, v[164:167] offset:0
  ds_write_b128 v44, v[168:171] offset:0
  ds_write_b128 v45, v[172:175] offset:0
  ds_write_b128 v42, v[176:179] offset:4096
  ds_write_b128 v43, v[180:183] offset:4096
  ds_write_b128 v44, v[184:187] offset:4096
  ds_write_b128 v45, v[188:191] offset:4096
  s_waitcnt lgkmcnt(0)
  ds_read_b64_tr_b16 v[160:161], v46 offset:0
  ds_read_b64_tr_b16 v[162:163], v48 offset:512
  ds_read_b64_tr_b16 v[164:165], v46 offset:2048
  ds_read_b64_tr_b16 v[166:167], v48 offset:2560
  ds_read_b64_tr_b16 v[168:169], v46 offset:4096
  ds_read_b64_tr_b16 v[170:171], v48 offset:4608
  ds_read_b64_tr_b16 v[172:173], v46 offset:6144
  ds_read_b64_tr_b16 v[174:175], v48 offset:6656
  ds_read_b64_tr_b16 v[176:177], v47 offset:256
  ds_read_b64_tr_b16 v[178:179], v49 offset:768
  ds_read_b64_tr_b16 v[180:181], v47 offset:2304
  ds_read_b64_tr_b16 v[182:183], v49 offset:2816
  ds_read_b64_tr_b16 v[184:185], v47 offset:4352
  ds_read_b64_tr_b16 v[186:187], v49 offset:4864
  ds_read_b64_tr_b16 v[188:189], v47 offset:6400
  ds_read_b64_tr_b16 v[190:191], v49 offset:6912
  s_waitcnt lgkmcnt(0)
  s_waitcnt vmcnt(8)
  ds_write_b128 v42, v[192:195] offset:0
  ds_write_b128 v43, v[196:199] offset:0
  ds_write_b128 v44, v[200:203] offset:0
  ds_write_b128 v45, v[204:207] offset:0
  ds_write_b128 v42, v[208:211] offset:4096
  ds_write_b128 v43, v[212:215] offset:4096
  ds_write_b128 v44, v[216:219] offset:4096
  ds_write_b128 v45, v[220:223] offset:4096
  s_waitcnt lgkmcnt(0)
  ds_read_b64_tr_b16 v[192:193], v46 offset:0
  ds_read_b64_tr_b16 v[194:195], v48 offset:512
  ds_read_b64_tr_b16 v[196:197], v46 offset:2048
  ds_read_b64_tr_b16 v[198:199], v48 offset:2560
  ds_read_b64_tr_b16 v[200:201], v46 offset:4096
  ds_read_b64_tr_b16 v[202:203], v48 offset:4608
  ds_read_b64_tr_b16 v[204:205], v46 offset:6144
  ds_read_b64_tr_b16 v[206:207], v48 offset:6656
  ds_read_b64_tr_b16 v[208:209], v47 offset:256
  ds_read_b64_tr_b16 v[210:211], v49 offset:768
  ds_read_b64_tr_b16 v[212:213], v47 offset:2304
  ds_read_b64_tr_b16 v[214:215], v49 offset:2816
  ds_read_b64_tr_b16 v[216:217], v47 offset:4352
  ds_read_b64_tr_b16 v[218:219], v49 offset:4864
  ds_read_b64_tr_b16 v[220:221], v47 offset:6400
  ds_read_b64_tr_b16 v[222:223], v49 offset:6912
  s_waitcnt lgkmcnt(0)
  s_waitcnt vmcnt(0)
  ds_write_b128 v42, v[224:227] offset:0
  ds_write_b128 v43, v[228:231] offset:0
  ds_write_b128 v44, v[232:235] offset:0
  ds_write_b128 v45, v[236:239] offset:0
  ds_write_b128 v42, v[240:243] offset:4096
  ds_write_b128 v43, v[244:247] offset:4096
  ds_write_b128 v44, v[248:251] offset:4096
  ds_write_b128 v45, v[252:255] offset:4096
  s_waitcnt lgkmcnt(0)
  ds_read_b64_tr_b16 v[224:225], v46 offset:0
  ds_read_b64_tr_b16 v[226:227], v48 offset:512
  ds_read_b64_tr_b16 v[228:229], v46 offset:2048
  ds_read_b64_tr_b16 v[230:231], v48 offset:2560
  ds_read_b64_tr_b16 v[232:233], v46 offset:4096
  ds_read_b64_tr_b16 v[234:235], v48 offset:4608
  ds_read_b64_tr_b16 v[236:237], v46 offset:6144
  ds_read_b64_tr_b16 v[238:239], v48 offset:6656
  ds_read_b64_tr_b16 v[240:241], v47 offset:256
  ds_read_b64_tr_b16 v[242:243], v49 offset:768
  ds_read_b64_tr_b16 v[244:245], v47 offset:2304
  ds_read_b64_tr_b16 v[246:247], v49 offset:2816
  ds_read_b64_tr_b16 v[248:249], v47 offset:4352
  ds_read_b64_tr_b16 v[250:251], v49 offset:4864
  ds_read_b64_tr_b16 v[252:253], v47 offset:6400
  ds_read_b64_tr_b16 v[254:255], v49 offset:6912
  s_waitcnt lgkmcnt(0)
  s_mov_b32 s96, 1
  s_mov_b32 s48, 0
  v_and_b32 v22, 3, v0
  v_mov_b32 v73, 32
  v_mov_b32 v74, 32
  v_cmp_eq_u32 vcc, 1, v22
  v_mov_b32 v75, 256
  v_mov_b32 v76, 36
  v_cndmask_b32 v73, v73, v75, vcc
  v_cndmask_b32 v74, v74, v76, vcc
CH_WA:
  buffer_load_dword v23, v74, s[16:19], 0 offen sc1
  s_add_u32 s48, s48, 1
  s_cmp_gt_u32 s48, 1600000
  s_cbranch_scc1 K_ABORT
  s_waitcnt vmcnt(0)
  v_cmp_gt_u32 vcc, v73, v23
  s_cbranch_vccnz CH_WA
  s_barrier
  s_mov_b32 s42, 2
  v_mbcnt_lo_u32_b32 v96, -1, 0
  v_mbcnt_hi_u32_b32 v96, -1, v96
  v_and_b32 v97, 1, v96
  v_bfe_u32 v96, v96, 1, 1
  v_lshlrev_b32 v96, 6, v96
  v_add_u32 v96, v96, v97
  s_lshl_b32 s44, s20, 1
  v_add_u32 v96, s44, v96
  v_lshlrev_b32 v96, 7, v96
  s_mov_b32 s45, 66060288
  s_mov_b32 s96, 3
  s_mov_b32 s48, 0
CH_KV0:
  buffer_load_dword v97, v96, s[8:11], s45 offen sc1
  s_add_u32 s48, s48, 1
  s_cmp_gt_u32 s48, 1600000
  s_cbranch_scc1 K_ABORT
  s_waitcnt vmcnt(0)
  v_readlane_b32 s44, v97, 0
  v_readlane_b32 s46, v97, 2
  s_nop 3
  s_min_u32 s44, s44, s46
  s_lshl_b32 s32, s44, 1
  v_readlane_b32 s44, v97, 1
  v_readlane_b32 s46, v97, 3
  s_nop 3
  s_min_u32 s44, s44, s46
  s_lshl_b32 s44, s44, 1
  s_add_u32 s44, s44, 1
  s_min_u32 s32, s32, s44
  s_cmp_ge_u32 s32, s42
  s_cbranch_scc0 CH_KV0
  s_mov_b32 s22, 0
  s_mov_b32 s23, 58720256
  s_lshl_b32 s40, s20, 13
  s_lshl_b32 s41, s21, 11
  s_add_u32 s40, s40, s41
  s_add_u32 s24, s40, 0
  s_add_u32 s25, s40, 16777216
  s_add_u32 s36, s41, 139264
  s_mov_b32 m0, s36
  s_add_u32 s42, s24, 1024
  buffer_load_dwordx4 v1, s[8:11], s24 offen lds
  s_add_u32 s43, s36, 1024
  s_mov_b32 m0, s43
  s_nop 0
  buffer_load_dwordx4 v1, s[8:11], s42 offen lds
  buffer_load_dwordx4 v[32:35], v1, s[8:11], s25 offen
  buffer_load_dwordx4 v[36:39], v1, s[8:11], s25 offen offset:1024
  s_add_u32 s24, s24, 262144
  s_add_u32 s25, s25, 262144
  s_add_u32 s36, s41, 147456
  s_lshl_b32 s40, s20, 11
  s_lshl_b32 s41, s21, 9
  s_add_u32 s40, s40, s41
  s_add_u32 s26, s40, 50331648
  s_add_u32 s27, s40, 54525952
  s_mov_b32 s30, 59768832
  s_mov_b32 s29, 59777024
  s_mov_b32 s38, 0x3e0293ee
  s_mov_b32 s39, 0x3e0293ee
  s_mov_b32 s35, 0
  s_mov_b32 s34, 0x2b800000
  s_lshl_b32 s33, s20, 7
  s_add_u32 s33, s33, 66093056
  s_mov_b32 s12, s66
  s_and_b32 s13, s67, 0xffff
  s_mov_b32 s14, 0x2000
  s_mov_b32 s15, 0x20000
  v_bfe_u32 v22, v0, 2, 2
  v_lshlrev_b32 v23, 11, v22
  v_bfe_u32 v22, v0, 0, 1
  v_lshl_add_u32 v23, v22, 10, v23
  v_bfe_u32 v22, v0, 1, 1
  v_lshl_add_u32 v23, v22, 6, v23
  v_bfe_u32 v22, v0, 4, 2
  v_lshl_add_u32 v23, v22, 3, v23
  s_lshl_b32 s40, s21, 8
  buffer_load_dwordx2 v[48:49], v23, s[12:15], s40 offen offset:0
  buffer_load_dwordx2 v[50:51], v23, s[12:15], s40 offen offset:32
  buffer_load_dwordx2 v[52:53], v23, s[12:15], s40 offen offset:128
  buffer_load_dwordx2 v[54:55], v23, s[12:15], s40 offen offset:160
  s_mov_b32 s41, 0x05040100
  s_mov_b32 s42, 0x07060302
  s_waitcnt vmcnt(0)
  v_perm_b32 v40, v50, v48, s41
  v_perm_b32 v41, v50, v48, s42
  v_perm_b32 v42, v51, v49, s41
  v_perm_b32 v43, v51, v49, s42
  v_perm_b32 v44, v54, v52, s41
  v_perm_b32 v45, v54, v52, s42
  v_perm_b32 v46, v55, v53, s41
  v_perm_b32 v47, v55, v53, s42
  ds_write_b128 v7, v[40:43]
  ds_write_b128 v7, v[44:47] offset:1024
  v_mov_b32 v48, -1
  v_mov_b32 v49, -1
  v_mov_b32 v50, -1
  v_mov_b32 v51, -1
  ds_read_b128 v[104:107], v11 offset:16384
  ds_read_b128 v[108:111], v11 offset:17408
  ds_read_b128 v[112:115], v11 offset:18432
  ds_read_b128 v[116:119], v11 offset:19456
  ds_read_b128 v[120:123], v11 offset:20480
  ds_read_b128 v[124:127], v11 offset:21504
  s_xor_b32 s37, s31, 262144
  v_mov_b64 v[72:73], 0
  v_mov_b64 v[74:75], 0
  v_mov_b64 v[76:77], 0
  v_mov_b64 v[78:79], 0
  v_mov_b64 v[80:81], 0
  v_mov_b64 v[82:83], 0
  v_mov_b64 v[84:85], 0
  v_mov_b64 v[86:87], 0
  v_mov_b64 v[88:89], 0
  v_mov_b64 v[90:91], 0
  v_mov_b64 v[92:93], 0
  v_mov_b64 v[94:95], 0
  s_cmp_eq_u32 s21, 0
  s_cselect_b32 s40, 0, 0x40000000
  v_cmp_eq_u32 vcc, 0, v0
  v_mov_b32 v22, 0x40000000
  v_mov_b32 v23, s40
  v_cndmask_b32 v0, v22, v23, vcc
  s_waitcnt vmcnt(0) lgkmcnt(0)
  s_branch CH_A
CH_LOOP:
  s_cmp_eq_u32 s21, 0
  s_cbranch_scc0 CH_NOTRED
  s_waitcnt vmcnt(0)
  s_mov_b32 s48, 0
  s_mov_b32 s96, 4
CH_POLLP:
  s_mov_b32 s40, s23
  buffer_load_dwordx4 v[96:99], v3, s[8:11], s40 offen sc1
  s_add_u32 s40, s40, 32768
  buffer_load_dwordx4 v[100:103], v3, s[8:11], s40 offen sc1
  s_add_u32 s40, s40, 32768
  buffer_load_dwordx4 v[104:107], v3, s[8:11], s40 offen sc1
  s_add_u32 s40, s40, 32768
  buffer_load_dwordx4 v[108:111], v3, s[8:11], s40 offen sc1
  s_add_u32 s40, s40, 32768
  buffer_load_dwordx4 v[112:115], v3, s[8:11], s40 offen sc1
  s_add_u32 s40, s40, 32768
  buffer_load_dwordx4 v[116:119], v3, s[8:11], s40 offen sc1
  s_add_u32 s40, s40, 32768
  buffer_load_dwordx4 v[120:123], v3, s[8:11], s40 offen sc1
  s_add_u32 s40, s40, 32768
  buffer_load_dwordx4 v[124:127], v3, s[8:11], s40 offen sc1
  s_add_u32 s48, s48, 1
  s_cmp_gt_u32 s48, 400000
  s_cbranch_scc1 CH_ABORT
  s_waitcnt vmcnt(7)
  v_mfma_f32_16x16x32_bf16 v[72:75], v[18:21], v[96:99], 0
  s_waitcnt vmcnt(6)
  v_mfma_f32_16x16x32_bf16 v[72:75], v[18:21], v[100:103], v[72:75]
  v_max_u32 v22, v96, v100
  s_waitcnt vmcnt(5)
  v_mfma_f32_16x16x32_bf16 v[72:75], v[18:21], v[104:107], v[72:75]
  s_waitcnt vmcnt(4)
  v_mfma_f32_16x16x32_bf16 v[72:75], v[18:21], v[108:111], v[72:75]
  v_max3_u32 v22, v22, v104, v108
  s_waitcnt vmcnt(3)
  v_mfma_f32_16x16x32_bf16 v[72:75], v[18:21], v[112:115], v[72:75]
  s_waitcnt vmcnt(2)
  v_mfma_f32_16x16x32_bf16 v[72:75], v[18:21], v[116:119], v[72:75]
  v_max3_u32 v22, v22, v112, v116
  s_waitcnt vmcnt(1)
  v_mfma_f32_16x16x32_bf16 v[72:75], v[18:21], v[120:123], v[72:75]
  s_waitcnt vmcnt(0)
  v_mfma_f32_16x16x32_bf16 v[72:75], v[18:21], v[124:127], v[72:75]
  v_max3_u32 v22, v22, v120, v124
  v_cmp_eq_u32 vcc, -1, v22
  s_nop 5
  v_cvt_pk_bf16_f32 v72, v72, v73
  v_min_u32 v72, -2, v72
  s_cbranch_vccnz CH_POLLP
  buffer_store_dword v72, v4, s[8:11], s29 offen
  s_barrier
  v_mov_b32 v23, -1
  buffer_store_dword v23, v4, s[8:11], s30 offen
  s_branch CH_HK
CH_NOTRED:
  s_barrier
CH_HK:
  s_xor_b32 s23, s23, 262144
  s_mov_b32 s30, s29
  s_lshl_b32 s40, s21, 11
  s_add_u32 s28, s30, s40
  s_add_u32 s29, s29, 8192
  s_cmp_ge_u32 s29, 59793408
  s_cselect_b32 s40, 24576, 0
  s_sub_u32 s29, s29, s40
  v_mov_b64 v[72:73], 0
  v_mov_b64 v[74:75], 0
  v_mov_b64 v[76:77], 0
  v_mov_b64 v[78:79], 0
  v_mov_b64 v[80:81], 0
  v_mov_b64 v[82:83], 0
  v_mov_b64 v[84:85], 0
  v_mov_b64 v[86:87], 0
  v_mov_b64 v[88:89], 0
  v_mov_b64 v[90:91], 0
  v_mov_b64 v[92:93], 0
  v_mov_b64 v[94:95], 0
CH_MENT:
  s_mov_b32 s48, 0
  s_mov_b32 s96, 5
  buffer_load_dwordx4 v[40:43], v1, s[8:11], s28 offen sc1
  buffer_load_dwordx4 v[44:47], v1, s[8:11], s28 offen offset:1024 sc1
  v_xor_b32 v17, 24576, v17
  s_xor_b32 s36, s36, 24576
  s_add_u32 s22, s22, 1
  s_mov_b32 s37, s31
  s_xor_b32 s31, s31, 262144
  s_cmp_lt_u32 s22, 63
  s_cselect_b32 s40, 262144, 0
  s_add_u32 s24, s24, s40
  s_add_u32 s25, s25, s40
  s_add_u32 s26, s26, 65536
  s_add_u32 s27, s27, 65536
  v_mov_b32 v48, -1
  v_mov_b32 v49, -1
  v_mov_b32 v50, -1
  v_mov_b32 v51, -1
  ds_read_b128 v[104:107], v11 offset:16384
  ds_read_b128 v[108:111], v11 offset:17408
  ds_read_b128 v[112:115], v11 offset:18432
  ds_read_b128 v[116:119], v11 offset:19456
  ds_read_b128 v[120:123], v11 offset:20480
  ds_read_b128 v[124:127], v11 offset:21504
  s_add_u32 s40, s22, 2
  s_min_u32 s40, s40, 64
  s_cmp_le_u32 s40, s32
  s_cbranch_scc0 CH_KVOL
CH_KVOK:
CH_POLLM:
  buffer_load_dwordx4 v[96:99], v1, s[8:11], s28 offen sc1
  buffer_load_dwordx4 v[100:103], v1, s[8:11], s28 offen offset:1024 sc1
  s_add_u32 s48, s48, 1
  s_cmp_gt_u32 s48, 400000
  s_cbranch_scc1 CH_ABORT
  s_waitcnt vmcnt(2)
  v_max_u32 v22, v40, v44
  v_cmp_eq_u32 vcc, -1, v22
  ds_write_b128 v7, v[40:43]
  ds_write_b128 v7, v[44:47] offset:1024
  s_cbranch_vccz CH_MOK
  buffer_load_dwordx4 v[40:43], v1, s[8:11], s28 offen sc1
  buffer_load_dwordx4 v[44:47], v1, s[8:11], s28 offen offset:1024 sc1
  s_add_u32 s48, s48, 1
  s_cmp_gt_u32 s48, 400000
  s_cbranch_scc1 CH_ABORT
  s_waitcnt vmcnt(2)
  v_max_u32 v22, v96, v100
  v_cmp_eq_u32 vcc, -1, v22
  ds_write_b128 v7, v[96:99]
  ds_write_b128 v7, v[100:103] offset:1024
  s_cbranch_vccnz CH_POLLM
  v_mov_b64 v[40:41], v[96:97]
  v_mov_b64 v[42:43], v[98:99]
  v_mov_b64 v[44:45], v[100:101]
  v_mov_b64 v[46:47], v[102:103]
CH_MOK:
  s_cmp_eq_u32 s22, 63
  s_cbranch_scc1 CH_DONE
CH_A:
  v_smfmac_f32_16x16x64_bf16 v[72:75], v[40:43], a[0:7], v2
  buffer_store_dwordx4 v[48:51], v1, s[8:11], s37 offen
  s_mov_b32 m0, s36
  s_waitcnt lgkmcnt(2)
  v_smfmac_f32_16x16x64_bf16 v[76:79], v[40:43], v[104:111], v2
  buffer_store_dwordx4 v[48:51], v1, s[8:11], s37 offen offset:1024
  s_add_u32 s40, s36, 1024
  v_mov_b64 v[24:25], v[32:33]
  v_smfmac_f32_16x16x64_bf16 v[80:83], v[40:43], a[128:135], v2
  buffer_load_dwordx4 v1, s[8:11], s24 offen lds
  s_mov_b32 m0, s40
  v_mov_b64 v[26:27], v[34:35]
  v_smfmac_f32_16x16x64_bf16 v[84:87], v[40:43], a[144:151], v2
  ds_read_b128 v[104:107], v11 offset:22528
  ds_read_b128 v[108:111], v11 offset:23552
  v_mov_b64 v[28:29], v[36:37]
  v_smfmac_f32_16x16x64_bf16 v[72:75], v[44:47], a[8:15], v2
  s_add_u32 s41, s24, 1024
  v_mov_b64 v[30:31], v[38:39]
  v_smfmac_f32_16x16x64_bf16 v[76:79], v[44:47], v[112:119], v2
  buffer_load_dwordx4 v1, s[8:11], s41 offen lds
  v_smfmac_f32_16x16x64_bf16 v[80:83], v[44:47], a[136:143], v2
  buffer_load_dwordx4 v[32:35], v1, s[8:11], s25 offen
  ds_read_b128 v[112:115], v11 offset:24576
  v_smfmac_f32_16x16x64_bf16 v[84:87], v[44:47], a[152:159], v2
  buffer_load_dwordx4 v[36:39], v1, s[8:11], s25 offen offset:1024
  ds_read_b128 v[116:119], v11 offset:25600
  v_smfmac_f32_16x16x64_bf16 v[88:91], v[40:43], v[128:135], v2
  s_waitcnt lgkmcnt(4)
  s_barrier
  v_smfmac_f32_16x16x64_bf16 v[92:95], v[40:43], v[144:151], v2
  ds_read_b128 v[48:51], v8 offset:0
  ds_read_b128 v[52:55], v8 offset:1024
  v_mov_b32 v23, s22
  v_smfmac_f32_16x16x64_bf16 v[88:91], v[44:47], v[136:143], v2
  ds_read_b128 v[56:59], v9 offset:0
  ds_read_b128 v[60:63], v9 offset:1024
  v_smfmac_f32_16x16x64_bf16 v[92:95], v[44:47], v[152:159], v2
  ds_read_b128 v[64:67], v10 offset:0
  ds_read_b128 v[68:71], v10 offset:1024
  buffer_store_dword v23, v0, s[8:11], s33 offen sc1
  s_waitcnt lgkmcnt(5)
  v_smfmac_f32_16x16x64_bf16 v[72:75], v[48:51], a[16:23], v2
  v_smfmac_f32_16x16x64_bf16 v[76:79], v[48:51], v[120:127], v2
  ds_read_b128 v[120:123], v11 offset:26624
  ds_read_b128 v[124:127], v11 offset:27648
  s_waitcnt lgkmcnt(6)
  v_smfmac_f32_16x16x64_bf16 v[72:75], v[52:55], a[24:31], v2
  v_smfmac_f32_16x16x64_bf16 v[76:79], v[52:55], v[104:111], v2
  ds_read_b128 v[104:107], v11 offset:28672
  ds_read_b128 v[108:111], v11 offset:29696
  s_waitcnt lgkmcnt(7)
  v_smfmac_f32_16x16x64_bf16 v[72:75], v[56:59], a[32:39], v2
  v_smfmac_f32_16x16x64_bf16 v[76:79], v[56:59], v[112:119], v2
  ds_read_b128 v[112:115], v11 offset:30720
  ds_read_b128 v[116:119], v11 offset:31744
  s_waitcnt lgkmcnt(8)
  v_smfmac_f32_16x16x64_bf16 v[72:75], v[60:63], a[40:47], v2
  s_waitcnt lgkmcnt(4)
  v_smfmac_f32_16x16x64_bf16 v[76:79], v[60:63], v[120:127], v2
  v_smfmac_f32_16x16x64_bf16 v[72:75], v[64:67], a[48:55], v2
  s_waitcnt lgkmcnt(2)
  v_smfmac_f32_16x16x64_bf16 v[76:79], v[64:67], v[104:111], v2
  v_smfmac_f32_16x16x64_bf16 v[72:75], v[68:71], a[56:63], v2
  s_waitcnt lgkmcnt(0)
  v_smfmac_f32_16x16x64_bf16 v[76:79], v[68:71], v[112:119], v2
  s_waitcnt vmcnt(7)
  v_smfmac_f32_16x16x64_bf16 v[80:83], v[48:51], a[160:167], v2
  ds_read_b128 v[96:99], v17 offset:0
  v_smfmac_f32_16x16x64_bf16 v[84:87], v[48:51], a[176:183], v2
  ds_read_b128 v[100:103], v17 offset:1024
  v_smfmac_f32_16x16x64_bf16 v[80:83], v[52:55], a[168:175], v2
  ds_read_b128 v[104:107], v17 offset:2048
  v_add_f32 v72, v72, v74
  v_add_f32 v73, v73, v75
  v_smfmac_f32_16x16x64_bf16 v[84:87], v[52:55], a[184:191], v2
  ds_read_b128 v[108:111], v17 offset:3072
  v_add_f32 v76, v76, v78
  v_add_f32 v77, v77, v79
  v_smfmac_f32_16x16x64_bf16 v[80:83], v[56:59], a[192:199], v2
  ds_read_b128 v[112:115], v17 offset:4096
  v_mul_f32 v72, s38, v72
  v_mul_f32 v73, s38, v73
  v_smfmac_f32_16x16x64_bf16 v[84:87], v[56:59], a[208:215], v2
  ds_read_b128 v[116:119], v17 offset:5120
  v_mul_f32 v76, s38, v76
  v_mul_f32 v77, s38, v77
  v_smfmac_f32_16x16x64_bf16 v[80:83], v[60:63], a[200:207], v2
  ds_read_b128 v[120:123], v17 offset:6144
  v_cvt_pk_bf16_f32 v22, v72, v73
  v_smfmac_f32_16x16x64_bf16 v[84:87], v[60:63], a[216:223], v2
  ds_read_b128 v[124:127], v17 offset:7168
  v_cvt_pk_bf16_f32 v23, v76, v77
  v_smfmac_f32_16x16x64_bf16 v[80:83], v[64:67], a[224:231], v2
  ds_write_b32 v12, v22
  v_smfmac_f32_16x16x64_bf16 v[84:87], v[64:67], a[240:247], v2
  ds_write_b32 v12, v23 offset:256
  v_smfmac_f32_16x16x64_bf16 v[80:83], v[68:71], a[232:239], v2
  v_smfmac_f32_16x16x64_bf16 v[84:87], v[68:71], a[248:255], v2
  v_smfmac_f32_16x16x64_bf16 v[88:91], v[48:51], v[160:167], v2
  v_smfmac_f32_16x16x64_bf16 v[92:95], v[48:51], v[176:183], v2
  s_waitcnt lgkmcnt(0)
  s_barrier
  v_smfmac_f32_16x16x64_bf16 v[88:91], v[52:55], v[168:175], v2
  ds_read_b64_tr_b16 v[40:41], v14 offset:0
  ds_read_b64_tr_b16 v[42:43], v14 offset:128
  v_add_f32 v80, v80, v82
  v_smfmac_f32_16x16x64_bf16 v[92:95], v[52:55], v[184:191], v2
  ds_read_b64_tr_b16 v[44:45], v14 offset:512
  ds_read_b64_tr_b16 v[46:47], v14 offset:640
  v_add_f32 v81, v81, v83
  v_smfmac_f32_16x16x64_bf16 v[88:91], v[56:59], v[192:199], v2
  ds_read_b64_tr_b16 v[72:73], v14 offset:1024
  ds_read_b64_tr_b16 v[74:75], v14 offset:1152
  v_add_f32 v84, v84, v86
  v_smfmac_f32_16x16x64_bf16 v[92:95], v[56:59], v[208:215], v2
  ds_read_b64_tr_b16 v[76:77], v14 offset:1536
  ds_read_b64_tr_b16 v[78:79], v14 offset:1664
  v_add_f32 v85, v85, v87
  v_smfmac_f32_16x16x64_bf16 v[88:91], v[60:63], v[200:207], v2
  v_cvt_pk_bf16_f32 v22, v80, v81
  v_smfmac_f32_16x16x64_bf16 v[92:95], v[60:63], v[216:223], v2
  ds_write_b32 v13, v22
  v_cvt_pk_bf16_f32 v23, v84, v85
  v_smfmac_f32_16x16x64_bf16 v[88:91], v[64:67], v[224:231], v2
  ds_write_b32 v13, v23 offset:256
  v_mov_b32 v60, 0xc1000000
  v_smfmac_f32_16x16x64_bf16 v[92:95], v[64:67], v[240:247], v2
  buffer_store_dword v22, v5, s[8:11], s26 offen offset:0 sc1
  v_mov_b32 v61, 0xc1000000
  v_smfmac_f32_16x16x64_bf16 v[88:91], v[68:71], v[232:239], v2
  v_mov_b32 v62, 0xc1000000
  v_mov_b32 v63, 0xc1000000
  v_smfmac_f32_16x16x64_bf16 v[92:95], v[68:71], v[248:255], v2
  s_waitcnt lgkmcnt(2)
  v_mfma_f32_16x16x32_bf16 v[48:51], v[96:99], v[40:43], v[60:63]
  buffer_store_dword v23, v5, s[8:11], s26 offen offset:256 sc1
  v_mov_b32 v56, 0xc1000000
  v_mov_b32 v57, 0xc1000000
  v_mfma_f32_16x16x32_bf16 v[52:55], v[112:115], v[40:43], v[60:63]
  s_waitcnt lgkmcnt(0)
  s_barrier
  v_mov_b64 v[58:59], 0
  v_mfma_f32_16x16x32_bf16 v[48:51], v[100:103], v[44:47], v[48:51]
  ds_read_b64_tr_b16 v[80:81], v15 offset:0
  ds_read_b64_tr_b16 v[82:83], v15 offset:64
  v_add_f32 v88, v88, v90
  v_add_f32 v89, v89, v91
  v_mfma_f32_16x16x32_bf16 v[52:55], v[116:119], v[44:47], v[52:55]
  ds_read_b64_tr_b16 v[84:85], v15 offset:1024
  ds_read_b64_tr_b16 v[86:87], v15 offset:1088
  v_add_f32 v92, v92, v94
  v_add_f32 v93, v93, v95
  v_mfma_f32_16x16x32_bf16 v[48:51], v[104:107], v[72:75], v[48:51]
  v_cvt_pk_bf16_f32 v88, v88, v89
  v_cvt_pk_bf16_f32 v92, v92, v93
  v_mfma_f32_16x16x32_bf16 v[52:55], v[120:123], v[72:75], v[52:55]
  v_mov_b32 v89, 0
  v_mov_b32 v93, 0
  v_mfma_f32_16x16x32_bf16 v[48:51], v[108:111], v[76:79], v[48:51]
  buffer_store_dword v88, v5, s[8:11], s27 offen offset:0 sc1
  v_mov_b32 v60, 0x3f803f80
  v_mov_b32 v61, 0x3f803f80
  v_mfma_f32_16x16x32_bf16 v[52:55], v[124:127], v[76:79], v[52:55]
  s_waitcnt lgkmcnt(0)
  v_mov_b32 v62, 0x3f803f80
  v_mov_b32 v63, 0x3f803f80
  v_smfmac_f32_16x16x64_bf16 v[56:59], v[80:83], v[40:47], v2
  ds_read_b128 v[96:99], v11 offset:0
  ds_read_b128 v[100:103], v11 offset:1024
  v_smfmac_f32_16x16x64_bf16 v[56:59], v[84:87], v[72:79], v2
  ds_read_b128 v[104:107], v11 offset:2048
  ds_read_b128 v[108:111], v11 offset:3072
  v_mov_b32 v45, 0
  ds_read_b128 v[112:115], v11 offset:4096
  ds_read_b128 v[116:119], v11 offset:5120
  v_exp_f32 v72, v48
  v_exp_f32 v73, v49
  v_exp_f32 v74, v50
  v_exp_f32 v75, v51
  ds_read_b128 v[120:123], v11 offset:6144
  ds_read_b128 v[124:127], v11 offset:7168
  buffer_store_dword v92, v5, s[8:11], s27 offen offset:256 sc1
  v_exp_f32 v76, v52
  v_exp_f32 v77, v53
  v_exp_f32 v78, v54
  v_exp_f32 v79, v55
  v_add_f32 v56, v56, v58
  v_add_f32 v57, v57, v59
  v_cvt_pk_bf16_f32 v40, v72, v73
  v_exp_f32 v80, v56
  v_exp_f32 v81, v57
  v_cvt_pk_bf16_f32 v41, v74, v75
  v_cvt_pk_bf16_f32 v42, v76, v77
  v_cvt_pk_bf16_f32 v43, v78, v79
  v_cvt_pk_bf16_f32 v44, v80, v81
  s_nop 0
  v_mfma_f32_16x16x32_bf16 v[84:87], v[60:63], v[40:43], 0
  v_mov_b64 v[64:65], 0
  v_mov_b64 v[66:67], 0
  v_mfma_f32_16x16x32_bf16 v[76:79], v[24:27], v[40:43], 0
  v_mov_b64 v[68:69], 0
  v_mov_b64 v[70:71], 0
  v_mfma_f32_16x16x32_bf16 v[80:83], v[28:31], v[40:43], 0
  v_mov_b64 v[46:47], 0
  v_mov_b64 v[58:59], 0
  v_mfma_f32_16x16x16_bf16 v[84:87], v[60:61], v[44:45], v[84:87]
  s_nop 1
  v_mfma_f32_16x16x16_bf16 v[76:79], v[88:89], v[44:45], v[76:79]
  s_nop 1
  v_mfma_f32_16x16x16_bf16 v[80:83], v[92:93], v[44:45], v[80:83]
  s_nop 1
  v_rcp_f32 v22, v84
  v_cmp_nge_f32 vcc, 1.0, v84
  v_cmp_nle_f32 s[44:45], s34, v84
  s_nop 1
  v_pk_mul_f32 v[76:77], v[76:77], v[22:23] op_sel_hi:[1,0]
  v_pk_mul_f32 v[78:79], v[78:79], v[22:23] op_sel_hi:[1,0]
  v_pk_mul_f32 v[80:81], v[80:81], v[22:23] op_sel_hi:[1,0]
  v_pk_mul_f32 v[82:83], v[82:83], v[22:23] op_sel_hi:[1,0]
  s_or_b64 vcc, vcc, s[44:45]
  s_cbranch_vccnz CH_FB
CH_CVT:
  v_cvt_pk_bf16_f32 v92, v76, v77
  v_cvt_pk_bf16_f32 v93, v78, v79
  v_cvt_pk_bf16_f32 v94, v80, v81
  ds_write_b64 v16, v[92:93]
  v_cvt_pk_bf16_f32 v95, v82, v83
  ds_write_b64 v16, v[94:95] offset:512
  v_mov_b64 v[40:41], 0
  v_mov_b64 v[42:43], 0
  v_mov_b64 v[44:45], 0
  v_mov_b64 v[48:49], 0
  v_mov_b64 v[50:51], 0
  v_mov_b64 v[52:53], 0
  v_mov_b64 v[54:55], 0
  v_mov_b64 v[56:57], 0
  v_mov_b64 v[60:61], 0
  v_mov_b64 v[62:63], 0
  s_waitcnt lgkmcnt(0)
  s_barrier
  ds_read_b128 v[24:27], v6 offset:28672
  ds_read_b128 v[28:31], v6 offset:29696
  ds_read_b128 v[72:75], v11 offset:8192
  ds_read_b128 v[76:79], v11 offset:9216
  ds_read_b128 v[80:83], v11 offset:10240
  ds_read_b128 v[84:87], v11 offset:11264
  ds_read_b128 v[88:91], v11 offset:12288
  ds_read_b128 v[92:95], v11 offset:13312
  s_waitcnt vmcnt(9)
  s_waitcnt lgkmcnt(6)
  v_smfmac_f32_16x16x64_bf16 v[40:43], v[24:27], v[96:103], v2
  ds_read_b128 v[96:99], v11 offset:14336
  ds_read_b128 v[100:103], v11 offset:15360
  v_smfmac_f32_16x16x64_bf16 v[40:43], v[28:31], v[104:111], v2
  v_smfmac_f32_16x16x64_bf16 v[44:47], v[24:27], v[112:119], v2
  v_smfmac_f32_16x16x64_bf16 v[44:47], v[28:31], v[120:127], v2
  s_waitcnt lgkmcnt(6)
  v_smfmac_f32_16x16x64_bf16 v[48:51], v[24:27], v[72:79], v2
  v_add_f32 v40, v40, v42
  v_add_f32 v41, v41, v43
  s_waitcnt lgkmcnt(4)
  v_smfmac_f32_16x16x64_bf16 v[48:51], v[28:31], v[80:87], v2
  v_cvt_pk_bf16_f32 v40, v40, v41
  v_min_u32 v40, -2, v40
  s_waitcnt lgkmcnt(2)
  v_smfmac_f32_16x16x64_bf16 v[52:55], v[24:27], v[88:95], v2
  v_add_f32 v44, v44, v46
  v_add_f32 v45, v45, v47
  s_waitcnt lgkmcnt(0)
  v_smfmac_f32_16x16x64_bf16 v[52:55], v[28:31], v[96:103], v2
  v_cvt_pk_bf16_f32 v41, v44, v45
  v_smfmac_f32_16x16x64_bf16 v[56:59], v[24:27], a[64:71], v2
  v_add_f32 v48, v48, v50
  v_add_f32 v49, v49, v51
  v_smfmac_f32_16x16x64_bf16 v[56:59], v[28:31], a[96:103], v2
  v_cvt_pk_bf16_f32 v42, v48, v49
  v_smfmac_f32_16x16x64_bf16 v[60:63], v[24:27], a[72:79], v2
  v_add_f32 v52, v52, v54
  v_add_f32 v53, v53, v55
  v_smfmac_f32_16x16x64_bf16 v[60:63], v[28:31], a[104:111], v2
  v_cvt_pk_bf16_f32 v43, v52, v53
  v_smfmac_f32_16x16x64_bf16 v[64:67], v[24:27], a[80:87], v2
  buffer_store_dwordx4 v[40:43], v1, s[8:11], s31 offen offset:0
  v_add_f32 v56, v56, v58
  v_add_f32 v57, v57, v59
  v_smfmac_f32_16x16x64_bf16 v[64:67], v[28:31], a[112:119], v2
  v_cvt_pk_bf16_f32 v56, v56, v57
  v_min_u32 v56, -2, v56
  v_smfmac_f32_16x16x64_bf16 v[68:71], v[24:27], a[88:95], v2
  v_add_f32 v60, v60, v62
  v_add_f32 v61, v61, v63
  v_smfmac_f32_16x16x64_bf16 v[68:71], v[28:31], a[120:127], v2
  v_cvt_pk_bf16_f32 v57, v60, v61
  v_add_f32 v64, v64, v66
  v_add_f32 v65, v65, v67
  v_cvt_pk_bf16_f32 v58, v64, v65
  s_nop 3
  v_add_f32 v68, v68, v70
  v_add_f32 v69, v69, v71
  v_cvt_pk_bf16_f32 v59, v68, v69
  buffer_store_dwordx4 v[56:59], v1, s[8:11], s31 offen offset:1024
  s_branch CH_LOOP
CH_KVOL:
  v_mbcnt_lo_u32_b32 v96, -1, 0
  v_mbcnt_hi_u32_b32 v96, -1, v96
  v_and_b32 v97, 1, v96
  v_bfe_u32 v96, v96, 1, 1
  v_lshlrev_b32 v96, 6, v96
  v_add_u32 v96, v96, v97
  s_lshl_b32 s44, s20, 1
  v_add_u32 v96, s44, v96
  v_lshlrev_b32 v96, 7, v96
  s_mov_b32 s45, 66060288
  s_mov_b32 s96, 3
  s_mov_b32 s48, 0
CH_KVW:
  buffer_load_dword v97, v96, s[8:11], s45 offen sc1
  s_add_u32 s48, s48, 1
  s_cmp_gt_u32 s48, 1600000
  s_cbranch_scc1 CH_ABORT
  s_waitcnt vmcnt(0)
  v_readlane_b32 s44, v97, 0
  v_readlane_b32 s46, v97, 2
  s_nop 3
  s_min_u32 s44, s44, s46
  s_lshl_b32 s32, s44, 1
  v_readlane_b32 s44, v97, 1
  v_readlane_b32 s46, v97, 3
  s_nop 3
  s_min_u32 s44, s44, s46
  s_lshl_b32 s44, s44, 1
  s_add_u32 s44, s44, 1
  s_min_u32 s32, s32, s44
  s_cmp_ge_u32 s32, s40
  s_cbranch_scc0 CH_KVW
  s_branch CH_KVOK
CH_FB:
  v_max3_f32 v22, v48, v49, v50
  v_max3_f32 v23, v52, v53, v54
  v_max3_f32 v22, v22, v51, v55
  v_max3_f32 v23, v23, v56, v57
  v_max_f32 v22, v22, v23
  v_mov_b32 v23, v22
  s_nop 1
  v_permlane16_swap_b32 v22, v23
  s_nop 0
  v_max_f32 v22, v22, v23
  v_mov_b32 v23, v22
  s_nop 1
  v_permlane32_swap_b32 v22, v23
  s_nop 0
  v_max_f32 v22, v22, v23
  v_sub_f32 v72, v48, v22
  v_sub_f32 v73, v49, v22
  v_sub_f32 v74, v50, v22
  v_sub_f32 v75, v51, v22
  v_sub_f32 v76, v52, v22
  v_sub_f32 v77, v53, v22
  v_sub_f32 v78, v54, v22
  v_sub_f32 v79, v55, v22
  v_sub_f32 v80, v56, v22
  v_sub_f32 v81, v57, v22
  v_exp_f32 v72, v72
  v_exp_f32 v73, v73
  v_exp_f32 v74, v74
  v_exp_f32 v75, v75
  v_exp_f32 v76, v76
  v_exp_f32 v77, v77
  v_exp_f32 v78, v78
  v_exp_f32 v79, v79
  v_exp_f32 v80, v80
  v_exp_f32 v81, v81
  s_nop 0
  v_cvt_pk_bf16_f32 v40, v72, v73
  v_cvt_pk_bf16_f32 v41, v74, v75
  v_cvt_pk_bf16_f32 v42, v76, v77
  v_cvt_pk_bf16_f32 v43, v78, v79
  v_cvt_pk_bf16_f32 v44, v80, v81
  s_nop 1
  v_mfma_f32_16x16x32_bf16 v[84:87], v[60:63], v[40:43], 0
  v_mov_b64 v[64:65], 0
  v_mov_b64 v[66:67], 0
  v_mfma_f32_16x16x32_bf16 v[76:79], v[24:27], v[40:43], 0
  v_mov_b64 v[68:69], 0
  v_mov_b64 v[70:71], 0
  v_mfma_f32_16x16x32_bf16 v[80:83], v[28:31], v[40:43], 0
  v_mov_b64 v[46:47], 0
  v_mov_b64 v[58:59], 0
  v_mfma_f32_16x16x16_bf16 v[84:87], v[60:61], v[44:45], v[84:87]
  s_nop 1
  v_mfma_f32_16x16x16_bf16 v[76:79], v[88:89], v[44:45], v[76:79]
  s_nop 1
  v_mfma_f32_16x16x16_bf16 v[80:83], v[92:93], v[44:45], v[80:83]
  s_nop 1
  s_nop 7
  v_rcp_f32 v22, v84
  s_nop 0
  v_pk_mul_f32 v[76:77], v[76:77], v[22:23] op_sel_hi:[1,0]
  v_pk_mul_f32 v[78:79], v[78:79], v[22:23] op_sel_hi:[1,0]
  v_pk_mul_f32 v[80:81], v[80:81], v[22:23] op_sel_hi:[1,0]
  v_pk_mul_f32 v[82:83], v[82:83], v[22:23] op_sel_hi:[1,0]
  s_branch CH_CVT
CH_ABORT:
  s_mov_b64 exec, -1
  s_mov_b32 s97, s22
  s_mov_b32 s22, 0xdead
CH_DONE:
  s_cmp_eq_u32 s22, 63
  s_cbranch_scc0 K_ABORT
  s_waitcnt lgkmcnt(0)
  s_barrier
  ds_read_b128 v[48:51], v8 offset:0
  ds_read_b128 v[52:55], v8 offset:1024
  ds_read_b128 v[56:59], v9 offset:0
  ds_read_b128 v[60:63], v9 offset:1024
  ds_read_b128 v[64:67], v10 offset:0
  ds_read_b128 v[68:71], v10 offset:1024
  v_mov_b32 v23, s22
  buffer_store_dword v23, v0, s[8:11], s33 offen sc1
  s_waitcnt lgkmcnt(0)
  v_smfmac_f32_16x16x64_bf16 v[80:83], v[40:43], a[128:135], v2
  v_smfmac_f32_16x16x64_bf16 v[88:91], v[40:43], v[128:135], v2
  v_smfmac_f32_16x16x64_bf16 v[84:87], v[40:43], a[144:151], v2
  v_smfmac_f32_16x16x64_bf16 v[92:95], v[40:43], v[144:151], v2
  v_smfmac_f32_16x16x64_bf16 v[80:83], v[44:47], a[136:143], v2
  v_smfmac_f32_16x16x64_bf16 v[88:91], v[44:47], v[136:143], v2
  v_smfmac_f32_16x16x64_bf16 v[84:87], v[44:47], a[152:159], v2
  v_smfmac_f32_16x16x64_bf16 v[92:95], v[44:47], v[152:159], v2
  v_smfmac_f32_16x16x64_bf16 v[80:83], v[48:51], a[160:167], v2
  v_smfmac_f32_16x16x64_bf16 v[88:91], v[48:51], v[160:167], v2
  v_smfmac_f32_16x16x64_bf16 v[84:87], v[48:51], a[176:183], v2
  v_smfmac_f32_16x16x64_bf16 v[92:95], v[48:51], v[176:183], v2
  v_smfmac_f32_16x16x64_bf16 v[80:83], v[52:55], a[168:175], v2
  v_smfmac_f32_16x16x64_bf16 v[88:91], v[52:55], v[168:175], v2
  v_smfmac_f32_16x16x64_bf16 v[84:87], v[52:55], a[184:191], v2
  v_smfmac_f32_16x16x64_bf16 v[92:95], v[52:55], v[184:191], v2
  v_smfmac_f32_16x16x64_bf16 v[80:83], v[56:59], a[192:199], v2
  v_smfmac_f32_16x16x64_bf16 v[88:91], v[56:59], v[192:199], v2
  v_smfmac_f32_16x16x64_bf16 v[84:87], v[56:59], a[208:215], v2
  v_smfmac_f32_16x16x64_bf16 v[92:95], v[56:59], v[208:215], v2
  v_smfmac_f32_16x16x64_bf16 v[80:83], v[60:63], a[200:207], v2
  v_smfmac_f32_16x16x64_bf16 v[88:91], v[60:63], v[200:207], v2
  v_smfmac_f32_16x16x64_bf16 v[84:87], v[60:63], a[216:223], v2
  v_smfmac_f32_16x16x64_bf16 v[92:95], v[60:63], v[216:223], v2
  v_smfmac_f32_16x16x64_bf16 v[80:83], v[64:67], a[224:231], v2
  v_smfmac_f32_16x16x64_bf16 v[88:91], v[64:67], v[224:231], v2
  v_smfmac_f32_16x16x64_bf16 v[84:87], v[64:67], a[240:247], v2
  v_smfmac_f32_16x16x64_bf16 v[92:95], v[64:67], v[240:247], v2
  v_smfmac_f32_16x16x64_bf16 v[80:83], v[68:71], a[232:239], v2
  v_smfmac_f32_16x16x64_bf16 v[88:91], v[68:71], v[232:239], v2
  v_smfmac_f32_16x16x64_bf16 v[84:87], v[68:71], a[248:255], v2
  v_smfmac_f32_16x16x64_bf16 v[92:95], v[68:71], v[248:255], v2
  s_nop 7
  s_nop 3
  v_add_f32 v80, v80, v82
  v_add_f32 v81, v81, v83
  v_cvt_pk_bf16_f32 v80, v80, v81
  v_add_f32 v84, v84, v86
  v_add_f32 v85, v85, v87
  v_cvt_pk_bf16_f32 v84, v84, v85
  v_add_f32 v88, v88, v90
  v_add_f32 v89, v89, v91
  v_cvt_pk_bf16_f32 v88, v88, v89
  v_add_f32 v92, v92, v94
  v_add_f32 v93, v93, v95
  v_cvt_pk_bf16_f32 v92, v92, v93
  buffer_store_dword v80, v5, s[8:11], s26 offen sc1
  buffer_store_dword v84, v5, s[8:11], s26 offen offset:256 sc1
  buffer_store_dword v88, v5, s[8:11], s27 offen sc1
  buffer_store_dword v92, v5, s[8:11], s27 offen offset:256 sc1
  s_waitcnt vmcnt(0)
  s_barrier
  v_mov_b32 v23, 64
  buffer_store_dword v23, v0, s[8:11], s33 offen sc1
  s_waitcnt vmcnt(0)
  s_branch K_END
K_WORKER:
  s_mov_b32 s63, 0
  s_mov_b32 s56, s88
  s_and_b32 s57, s89, 0xffff
  s_mov_b32 s58, 0x100
  s_mov_b32 s59, 0x20000
  s_cmp_eq_u32 s63, 0
  s_cbranch_scc0 K_NOI
  s_cmp_eq_u32 s21, 0
  s_cbranch_scc0 WI_NOINIT
  v_mov_b32 v22, 0
  v_lshlrev_b32 v23, 2, v0
  s_lshl_b32 s44, s95, 6
  s_add_u32 s44, s44, 66125824
  s_mov_b64 exec, 0xffff
  buffer_store_dword v22, v23, s[8:11], s44 offen sc1
  s_mov_b64 exec, 1
  s_lshl_b32 s44, s94, 7
  s_add_u32 s44, s44, 66060288
  s_lshl_b32 s45, s20, 7
  s_add_u32 s45, s45, 66093056
  s_cmp_eq_u32 s92, 0
  s_cselect_b32 s44, s45, s44
  buffer_store_dword v22, v23, s[8:11], s44 offen sc1
  s_mov_b64 exec, -1
WI_NOINIT:
K_NOI:
  v_lshlrev_b32 v1, 4, v0
  s_cmp_eq_u32 s21, 0
  s_cselect_b32 s40, 0, 0x40000000
  v_mov_b32 v19, s40
  v_and_b32 v20, 31, v0
  v_lshlrev_b32 v2, 10, v20
  v_lshrrev_b32 v21, 5, v0
  v_and_b32 v20, 15, v0
  v_xor_b32 v20, v20, v21
  v_xor_b32 v21, 14, v20
  v_lshl_add_u32 v9, v21, 4, v2
  v_xor_b32 v21, 12, v20
  v_lshl_add_u32 v8, v21, 4, v2
  v_xor_b32 v21, 10, v20
  v_lshl_add_u32 v7, v21, 4, v2
  v_xor_b32 v21, 8, v20
  v_lshl_add_u32 v6, v21, 4, v2
  v_xor_b32 v21, 6, v20
  v_lshl_add_u32 v5, v21, 4, v2
  v_xor_b32 v21, 4, v20
  v_lshl_add_u32 v4, v21, 4, v2
  v_xor_b32 v21, 2, v20
  v_lshl_add_u32 v3, v21, 4, v2
  v_xor_b32 v21, 0, v20
  v_lshl_add_u32 v2, v21, 4, v2
  s_and_b32 s40, s21, 1
  s_lshl_b32 s40, s40, 3
  s_add_u32 s41, s40, 0
  v_xor_b32 v20, s41, v0
  v_and_b32 v20, 15, v20
  v_and_b32 v21, 48, v0
  v_or_b32 v20, v20, v21
  v_lshlrev_b32 v10, 4, v20
  s_add_u32 s41, s40, 1
  v_xor_b32 v20, s41, v0
  v_and_b32 v20, 15, v20
  v_and_b32 v21, 48, v0
  v_or_b32 v20, v20, v21
  v_lshlrev_b32 v11, 4, v20
  s_add_u32 s41, s40, 2
  v_xor_b32 v20, s41, v0
  v_and_b32 v20, 15, v20
  v_and_b32 v21, 48, v0
  v_or_b32 v20, v20, v21
  v_lshlrev_b32 v12, 4, v20
  s_add_u32 s41, s40, 3
  v_xor_b32 v20, s41, v0
  v_and_b32 v20, 15, v20
  v_and_b32 v21, 48, v0
  v_or_b32 v20, v20, v21
  v_lshlrev_b32 v13, 4, v20
  s_add_u32 s41, s40, 4
  v_xor_b32 v20, s41, v0
  v_and_b32 v20, 15, v20
  v_and_b32 v21, 48, v0
  v_or_b32 v20, v20, v21
  v_lshlrev_b32 v14, 4, v20
  s_add_u32 s41, s40, 5
  v_xor_b32 v20, s41, v0
  v_and_b32 v20, 15, v20
  v_and_b32 v21, 48, v0
  v_or_b32 v20, v20, v21
  v_lshlrev_b32 v15, 4, v20
  s_add_u32 s41, s40, 6
  v_xor_b32 v20, s41, v0
  v_and_b32 v20, 15, v20
  v_and_b32 v21, 48, v0
  v_or_b32 v20, v20, v21
  v_lshlrev_b32 v16, 4, v20
  s_add_u32 s41, s40, 7
  v_xor_b32 v20, s41, v0
  v_and_b32 v20, 15, v20
  v_and_b32 v21, 48, v0
  v_or_b32 v20, v20, v21
  v_lshlrev_b32 v17, 4, v20
  s_mov_b32 s12, s64
  s_and_b32 s13, s65, 0xffff
  s_mov_b32 s14, 0x200000
  s_mov_b32 s15, 0x20000
  s_lshl_b32 s28, s94, 7
  s_add_u32 s28, s28, 66060288
  s_cmp_lt_u32 s94, 192
  s_cbranch_scc0 G_BROLE
  s_lshr_b32 s44, s94, 1
  s_and_b32 s24, s94, 1
  s_mov_b32 s25, 2
  s_mov_b32 s23, 32
  s_and_b32 s45, s44, 31
  s_lshr_b32 s44, s44, 5
  s_mov_b32 s32, 8192
  s_lshl_b32 s33, s45, 8
  s_lshl_b32 s40, s21, 6
  s_add_u32 s33, s33, s40
  s_mov_b32 s27, 262144
  s_lshl_b32 s26, s45, 13
  s_cmp_eq_u32 s44, 1
  s_cbranch_scc1 G_VROLE
  s_cmp_eq_u32 s44, 0
  s_cselect_b32 s40, s70, s68
  s_cselect_b32 s41, s71, s69
  s_cselect_b32 s42, 0, 33554432
  s_add_u32 s26, s26, s42
  s_mov_b32 s16, s40
  s_and_b32 s17, s41, 0xffff
  s_mov_b32 s18, 0x400000
  s_mov_b32 s19, 0x20000
  s_lshl_b32 s40, s21, 10
  s_add_u32 s26, s26, s40
  v_bfe_u32 v20, v0, 3, 1
  v_lshlrev_b32 v18, 12, v20
  v_bfe_u32 v20, v0, 5, 1
  v_lshl_add_u32 v18, v20, 8, v18
  v_bfe_u32 v20, v0, 4, 1
  v_lshl_add_u32 v18, v20, 7, v18
  v_bfe_u32 v20, v0, 2, 1
  v_lshl_add_u32 v18, v20, 6, v18
  v_bfe_u32 v20, v0, 0, 2
  v_lshl_add_u32 v18, v20, 4, v18
  v_lshrrev_b32 v20, 2, v0
  v_mul_lo_u32 v64, v20, s32
  v_and_b32 v20, 3, v0
  v_lshl_add_u32 v64, v20, 4, v64
  s_lshl_b32 s40, s21, 13
  s_add_u32 s40, s40, 98304
  v_bfe_u32 v20, v0, 4, 2
  v_lshlrev_b32 v65, 8, v20
  v_bfe_u32 v20, v0, 1, 1
  v_lshl_add_u32 v65, v20, 7, v65
  v_bfe_u32 v20, v0, 2, 2
  v_lshl_add_u32 v65, v20, 5, v65
  v_bfe_u32 v20, v0, 0, 1
  v_lshl_add_u32 v65, v20, 4, v65
  v_add_u32 v65, s40, v65
  v_bfe_u32 v20, v0, 5, 1
  v_lshlrev_b32 v66, 9, v20
  v_bfe_u32 v20, v0, 4, 1
  v_lshl_add_u32 v66, v20, 7, v66
  v_bfe_u32 v20, v0, 2, 2
  v_lshl_add_u32 v66, v20, 5, v66
  v_bfe_u32 v20, v0, 0, 2
  v_lshl_add_u32 v66, v20, 3, v66
  v_add_u32 v66, s40, v66
  s_lshl_b32 s41, s32, 4
  s_mov_b32 s40, s33
  buffer_load_dwordx4 a[0:3], v64, s[16:19], s40 offen
  s_add_u32 s40, s40, s41
  buffer_load_dwordx4 a[4:7], v64, s[16:19], s40 offen
  s_add_u32 s40, s40, s41
  buffer_load_dwordx4 a[8:11], v64, s[16:19], s40 offen
  s_add_u32 s40, s40, s41
  buffer_load_dwordx4 a[12:15], v64, s[16:19], s40 offen
  s_add_u32 s40, s40, s41
  buffer_load_dwordx4 a[16:19], v64, s[16:19], s40 offen
  s_add_u32 s40, s40, s41
  buffer_load_dwordx4 a[20:23], v64, s[16:19], s40 offen
  s_add_u32 s40, s40, s41
  buffer_load_dwordx4 a[24:27], v64, s[16:19], s40 offen
  s_add_u32 s40, s40, s41
  buffer_load_dwordx4 a[28:31], v64, s[16:19], s40 offen
  s_add_u32 s40, s40, s41
  buffer_load_dwordx4 a[32:35], v64, s[16:19], s40 offen
  s_add_u32 s40, s40, s41
  buffer_load_dwordx4 a[36:39], v64, s[16:19], s40 offen
  s_add_u32 s40, s40, s41
  buffer_load_dwordx4 a[40:43], v64, s[16:19], s40 offen
  s_add_u32 s40, s40, s41
  buffer_load_dwordx4 a[44:47], v64, s[16:19], s40 offen
  s_add_u32 s40, s40, s41
  buffer_load_dwordx4 a[48:51], v64, s[16:19], s40 offen
  s_add_u32 s40, s40, s41
  buffer_load_dwordx4 a[52:55], v64, s[16:19], s40 offen
  s_add_u32 s40, s40, s41
  buffer_load_dwordx4 a[56:59], v64, s[16:19], s40 offen
  s_add_u32 s40, s40, s41
  buffer_load_dwordx4 a[60:63], v64, s[16:19], s40 offen
  s_add_u32 s40, s40, s41
  buffer_load_dwordx4 a[64:67], v64, s[16:19], s40 offen
  s_add_u32 s40, s40, s41
  buffer_load_dwordx4 a[68:71], v64, s[16:19], s40 offen
  s_add_u32 s40, s40, s41
  buffer_load_dwordx4 a[72:75], v64, s[16:19], s40 offen
  s_add_u32 s40, s40, s41
  buffer_load_dwordx4 a[76:79], v64, s[16:19], s40 offen
  s_add_u32 s40, s40, s41
  buffer_load_dwordx4 a[80:83], v64, s[16:19], s40 offen
  s_add_u32 s40, s40, s41
  buffer_load_dwordx4 a[84:87], v64, s[16:19], s40 offen
  s_add_u32 s40, s40, s41
  buffer_load_dwordx4 a[88:91], v64, s[16:19], s40 offen
  s_add_u32 s40, s40, s41
  buffer_load_dwordx4 a[92:95], v64, s[16:19], s40 offen
  s_add_u32 s40, s40, s41
  buffer_load_dwordx4 a[96:99], v64, s[16:19], s40 offen
  s_add_u32 s40, s40, s41
  buffer_load_dwordx4 a[100:103], v64, s[16:19], s40 offen
  s_add_u32 s40, s40, s41
  buffer_load_dwordx4 a[104:107], v64, s[16:19], s40 offen
  s_add_u32 s40, s40, s41
  buffer_load_dwordx4 a[108:111], v64, s[16:19], s40 offen
  s_add_u32 s40, s40, s41
  buffer_load_dwordx4 a[112:115], v64, s[16:19], s40 offen
  s_add_u32 s40, s40, s41
  buffer_load_dwordx4 a[116:119], v64, s[16:19], s40 offen
  s_add_u32 s40, s40, s41
  buffer_load_dwordx4 a[120:123], v64, s[16:19], s40 offen
  s_add_u32 s40, s40, s41
  buffer_load_dwordx4 a[124:127], v64, s[16:19], s40 offen
  s_add_u32 s40, s40, s41
  s_lshl_b32 s40, s20, 10
  s_lshl_b32 s41, s21, 19
  s_lshl_b32 s41, s21, 15
  s_add_u32 s40, s40, s41
  buffer_load_dwordx4 v[72:75], v1, s[12:15], s40 offen
  s_add_u32 s40, s40, 131072
  buffer_load_dwordx4 v[76:79], v1, s[12:15], s40 offen
  s_add_u32 s40, s40, 131072
  buffer_load_dwordx4 v[80:83], v1, s[12:15], s40 offen
  s_add_u32 s40, s40, 131072
  buffer_load_dwordx4 v[84:87], v1, s[12:15], s40 offen
  s_add_u32 s40, s40, 131072
  buffer_load_dwordx4 v[72:75], v1, s[12:15], s40 offen
  s_add_u32 s40, s40, 131072
  buffer_load_dwordx4 v[76:79], v1, s[12:15], s40 offen
  s_add_u32 s40, s40, 131072
  buffer_load_dwordx4 v[80:83], v1, s[12:15], s40 offen
  s_add_u32 s40, s40, 131072
  buffer_load_dwordx4 v[84:87], v1, s[12:15], s40 offen
  s_add_u32 s40, s40, 131072
  buffer_load_dwordx4 v[72:75], v1, s[12:15], s40 offen
  s_add_u32 s40, s40, 131072
  buffer_load_dwordx4 v[76:79], v1, s[12:15], s40 offen
  s_add_u32 s40, s40, 131072
  buffer_load_dwordx4 v[80:83], v1, s[12:15], s40 offen
  s_add_u32 s40, s40, 131072
  buffer_load_dwordx4 v[84:87], v1, s[12:15], s40 offen
  s_add_u32 s40, s40, 131072
  buffer_load_dwordx4 v[72:75], v1, s[12:15], s40 offen
  s_add_u32 s40, s40, 131072
  buffer_load_dwordx4 v[76:79], v1, s[12:15], s40 offen
  s_add_u32 s40, s40, 131072
  buffer_load_dwordx4 v[80:83], v1, s[12:15], s40 offen
  s_add_u32 s40, s40, 131072
  buffer_load_dwordx4 v[84:87], v1, s[12:15], s40 offen
  s_add_u32 s40, s40, 131072
  s_waitcnt vmcnt(40)
  ds_write_b128 v65, a[0:3] offset:0
  ds_write_b128 v65, a[4:7] offset:1024
  ds_write_b128 v65, a[8:11] offset:2048
  ds_write_b128 v65, a[12:15] offset:3072
  ds_write_b128 v65, a[16:19] offset:4096
  ds_write_b128 v65, a[20:23] offset:5120
  ds_write_b128 v65, a[24:27] offset:6144
  ds_write_b128 v65, a[28:31] offset:7168
  s_waitcnt lgkmcnt(0)
  ds_read_b64_tr_b16 a[0:1], v66 offset:0
  ds_read_b64_tr_b16 a[2:3], v66 offset:256
  ds_read_b64_tr_b16 a[4:5], v66 offset:1024
  ds_read_b64_tr_b16 a[6:7], v66 offset:1280
  ds_read_b64_tr_b16 a[8:9], v66 offset:2048
  ds_read_b64_tr_b16 a[10:11], v66 offset:2304
  ds_read_b64_tr_b16 a[12:13], v66 offset:3072
  ds_read_b64_tr_b16 a[14:15], v66 offset:3328
  ds_read_b64_tr_b16 a[16:17], v66 offset:4096
  ds_read_b64_tr_b16 a[18:19], v66 offset:4352
  ds_read_b64_tr_b16 a[20:21], v66 offset:5120
  ds_read_b64_tr_b16 a[22:23], v66 offset:5376
  ds_read_b64_tr_b16 a[24:25], v66 offset:6144
  ds_read_b64_tr_b16 a[26:27], v66 offset:6400
  ds_read_b64_tr_b16 a[28:29], v66 offset:7168
  ds_read_b64_tr_b16 a[30:31], v66 offset:7424
  s_waitcnt lgkmcnt(0)
  s_waitcnt vmcnt(32)
  ds_write_b128 v65, a[32:35] offset:0
  ds_write_b128 v65, a[36:39] offset:1024
  ds_write_b128 v65, a[40:43] offset:2048
  ds_write_b128 v65, a[44:47] offset:3072
  ds_write_b128 v65, a[48:51] offset:4096
  ds_write_b128 v65, a[52:55] offset:5120
  ds_write_b128 v65, a[56:59] offset:6144
  ds_write_b128 v65, a[60:63] offset:7168
  s_waitcnt lgkmcnt(0)
  ds_read_b64_tr_b16 a[32:33], v66 offset:0
  ds_read_b64_tr_b16 a[34:35], v66 offset:256
  ds_read_b64_tr_b16 a[36:37], v66 offset:1024
  ds_read_b64_tr_b16 a[38:39], v66 offset:1280
  ds_read_b64_tr_b16 a[40:41], v66 offset:2048
  ds_read_b64_tr_b16 a[42:43], v66 offset:2304
  ds_read_b64_tr_b16 a[44:45], v66 offset:3072
  ds_read_b64_tr_b16 a[46:47], v66 offset:3328
  ds_read_b64_tr_b16 a[48:49], v66 offset:4096
  ds_read_b64_tr_b16 a[50:51], v66 offset:4352
  ds_read_b64_tr_b16 a[52:53], v66 offset:5120
  ds_read_b64_tr_b16 a[54:55], v66 offset:5376
  ds_read_b64_tr_b16 a[56:57], v66 offset:6144
  ds_read_b64_tr_b16 a[58:59], v66 offset:6400
  ds_read_b64_tr_b16 a[60:61], v66 offset:7168
  ds_read_b64_tr_b16 a[62:63], v66 offset:7424
  s_waitcnt lgkmcnt(0)
  s_waitcnt vmcnt(24)
  ds_write_b128 v65, a[64:67] offset:0
  ds_write_b128 v65, a[68:71] offset:1024
  ds_write_b128 v65, a[72:75] offset:2048
  ds_write_b128 v65, a[76:79] offset:3072
  ds_write_b128 v65, a[80:83] offset:4096
  ds_write_b128 v65, a[84:87] offset:5120
  ds_write_b128 v65, a[88:91] offset:6144
  ds_write_b128 v65, a[92:95] offset:7168
  s_waitcnt lgkmcnt(0)
  ds_read_b64_tr_b16 a[64:65], v66 offset:0
  ds_read_b64_tr_b16 a[66:67], v66 offset:256
  ds_read_b64_tr_b16 a[68:69], v66 offset:1024
  ds_read_b64_tr_b16 a[70:71], v66 offset:1280
  ds_read_b64_tr_b16 a[72:73], v66 offset:2048
  ds_read_b64_tr_b16 a[74:75], v66 offset:2304
  ds_read_b64_tr_b16 a[76:77], v66 offset:3072
  ds_read_b64_tr_b16 a[78:79], v66 offset:3328
  ds_read_b64_tr_b16 a[80:81], v66 offset:4096
  ds_read_b64_tr_b16 a[82:83], v66 offset:4352
  ds_read_b64_tr_b16 a[84:85], v66 offset:5120
  ds_read_b64_tr_b16 a[86:87], v66 offset:5376
  ds_read_b64_tr_b16 a[88:89], v66 offset:6144
  ds_read_b64_tr_b16 a[90:91], v66 offset:6400
  ds_read_b64_tr_b16 a[92:93], v66 offset:7168
  ds_read_b64_tr_b16 a[94:95], v66 offset:7424
  s_waitcnt lgkmcnt(0)
  s_waitcnt vmcnt(16)
  ds_write_b128 v65, a[96:99] offset:0
  ds_write_b128 v65, a[100:103] offset:1024
  ds_write_b128 v65, a[104:107] offset:2048
  ds_write_b128 v65, a[108:111] offset:3072
  ds_write_b128 v65, a[112:115] offset:4096
  ds_write_b128 v65, a[116:119] offset:5120
  ds_write_b128 v65, a[120:123] offset:6144
  ds_write_b128 v65, a[124:127] offset:7168
  s_waitcnt lgkmcnt(0)
  ds_read_b64_tr_b16 a[96:97], v66 offset:0
  ds_read_b64_tr_b16 a[98:99], v66 offset:256
  ds_read_b64_tr_b16 a[100:101], v66 offset:1024
  ds_read_b64_tr_b16 a[102:103], v66 offset:1280
  ds_read_b64_tr_b16 a[104:105], v66 offset:2048
  ds_read_b64_tr_b16 a[106:107], v66 offset:2304
  ds_read_b64_tr_b16 a[108:109], v66 offset:3072
  ds_read_b64_tr_b16 a[110:111], v66 offset:3328
  ds_read_b64_tr_b16 a[112:113], v66 offset:4096
  ds_read_b64_tr_b16 a[114:115], v66 offset:4352
  ds_read_b64_tr_b16 a[116:117], v66 offset:5120
  ds_read_b64_tr_b16 a[118:119], v66 offset:5376
  ds_read_b64_tr_b16 a[120:121], v66 offset:6144
  ds_read_b64_tr_b16 a[122:123], v66 offset:6400
  ds_read_b64_tr_b16 a[124:125], v66 offset:7168
  ds_read_b64_tr_b16 a[126:127], v66 offset:7424
  s_waitcnt lgkmcnt(0)
  s_cmp_eq_u32 s63, 0
  s_cbranch_scc0 H1_SKIP
  s_cmp_eq_u32 s21, 0
  s_cbranch_scc0 H1_NOSIG
  s_mov_b64 exec, 1
  v_mov_b32 v23, 1
  v_mov_b32 v22, 36
  buffer_atomic_add v23, v22, s[56:59], 0 offen
  s_mov_b64 exec, -1
H1_NOSIG:
H1_SKIP:
  s_mov_b32 s29, 0
  s_lshl_b32 s31, s24, 15
  s_mov_b32 s30, 0
  s_lshl_b32 s40, s21, 13
  s_add_u32 s41, s40, s31
  s_add_u32 s40, s40, s30
  s_mov_b32 m0, s40
  s_add_u32 s40, s40, 1024
  buffer_load_dwordx4 v10, s[12:15], s41 offen lds
  s_add_u32 s41, s41, 1024
  s_mov_b32 m0, s40
  s_add_u32 s40, s40, 1024
  buffer_load_dwordx4 v11, s[12:15], s41 offen lds
  s_add_u32 s41, s41, 1024
  s_mov_b32 m0, s40
  s_add_u32 s40, s40, 1024
  buffer_load_dwordx4 v12, s[12:15], s41 offen lds
  s_add_u32 s41, s41, 1024
  s_mov_b32 m0, s40
  s_add_u32 s40, s40, 1024
  buffer_load_dwordx4 v13, s[12:15], s41 offen lds
  s_add_u32 s41, s41, 1024
  s_mov_b32 m0, s40
  s_add_u32 s40, s40, 1024
  buffer_load_dwordx4 v14, s[12:15], s41 offen lds
  s_add_u32 s41, s41, 1024
  s_mov_b32 m0, s40
  s_add_u32 s40, s40, 1024
  buffer_load_dwordx4 v15, s[12:15], s41 offen lds
  s_add_u32 s41, s41, 1024
  s_mov_b32 m0, s40
  s_add_u32 s40, s40, 1024
  buffer_load_dwordx4 v16, s[12:15], s41 offen lds
  s_add_u32 s41, s41, 1024
  s_mov_b32 m0, s40
  s_nop 0
  buffer_load_dwordx4 v17, s[12:15], s41 offen lds
  s_lshl_b32 s42, s25, 15
  s_add_u32 s31, s31, s42
  s_mov_b32 s30, 32768
  s_lshl_b32 s40, s21, 13
  s_add_u32 s41, s40, s31
  s_add_u32 s40, s40, s30
  s_mov_b32 m0, s40
  s_add_u32 s40, s40, 1024
  buffer_load_dwordx4 v10, s[12:15], s41 offen lds
  s_add_u32 s41, s41, 1024
  s_mov_b32 m0, s40
  s_add_u32 s40, s40, 1024
  buffer_load_dwordx4 v11, s[12:15], s41 offen lds
  s_add_u32 s41, s41, 1024
  s_mov_b32 m0, s40
  s_add_u32 s40, s40, 1024
  buffer_load_dwordx4 v12, s[12:15], s41 offen lds
  s_add_u32 s41, s41, 1024
  s_mov_b32 m0, s40
  s_add_u32 s40, s40, 1024
  buffer_load_dwordx4 v13, s[12:15], s41 offen lds
  s_add_u32 s41, s41, 1024
  s_mov_b32 m0, s40
  s_add_u32 s40, s40, 1024
  buffer_load_dwordx4 v14, s[12:15], s41 offen lds
  s_add_u32 s41, s41, 1024
  s_mov_b32 m0, s40
  s_add_u32 s40, s40, 1024
  buffer_load_dwordx4 v15, s[12:15], s41 offen lds
  s_add_u32 s41, s41, 1024
  s_mov_b32 m0, s40
  s_add_u32 s40, s40, 1024
  buffer_load_dwordx4 v16, s[12:15], s41 offen lds
  s_add_u32 s41, s41, 1024
  s_mov_b32 m0, s40
  s_nop 0
  buffer_load_dwordx4 v17, s[12:15], s41 offen lds
  v_mov_b32 v21, 0x40000000
  buffer_store_dword v21, v21, s[8:11], 0 offen
  buffer_store_dword v21, v21, s[8:11], 0 offen
  s_mov_b32 s22, 0
  s_waitcnt vmcnt(10)
  s_branch GKQ_ENTER
GKQ_LOOP:
  s_waitcnt vmcnt(13)
GKQ_ENTER:
  s_barrier
  s_max_u32 s40, s22, 2
  s_sub_u32 s40, s40, 2
  v_mov_b32 v20, s40
  s_mov_b64 exec, 1
  buffer_store_dword v20, v19, s[8:11], s28 offen sc1
  s_mov_b64 exec, -1
  s_lshl_b32 s42, s25, 15
  s_add_u32 s31, s31, s42
  s_add_u32 s30, s30, 32768
  s_cmp_ge_u32 s30, 98304
  s_cselect_b32 s42, 98304, 0
  s_sub_u32 s30, s30, s42
  s_lshl_b32 s44, s21, 13
  s_add_u32 s45, s44, s31
  s_add_u32 s44, s44, s30
  ds_read_b128 v[40:43], v2 offset:0
  ds_read_b128 v[44:47], v3 offset:0
  ds_read_b128 v[48:51], v4 offset:0
  ds_read_b128 v[52:55], v5 offset:0
  s_waitcnt lgkmcnt(3)
  v_mfma_f32_32x32x16_bf16 v[24:39], a[0:3], v[40:43], 0
  ds_read_b128 v[40:43], v6 offset:0
  s_waitcnt lgkmcnt(3)
  v_mfma_f32_32x32x16_bf16 v[24:39], a[4:7], v[44:47], v[24:39]
  ds_read_b128 v[44:47], v7 offset:0
  s_mov_b32 m0, s44
  s_add_u32 s44, s44, 1024
  s_waitcnt lgkmcnt(3)
  v_mfma_f32_32x32x16_bf16 v[24:39], a[8:11], v[48:51], v[24:39]
  ds_read_b128 v[48:51], v8 offset:0
  buffer_load_dwordx4 v10, s[12:15], s45 offen lds
  s_add_u32 s45, s45, 1024
  s_waitcnt lgkmcnt(3)
  v_mfma_f32_32x32x16_bf16 v[24:39], a[12:15], v[52:55], v[24:39]
  ds_read_b128 v[52:55], v9 offset:0
  s_waitcnt lgkmcnt(3)
  v_mfma_f32_32x32x16_bf16 v[24:39], a[16:19], v[40:43], v[24:39]
  ds_read_b128 v[40:43], v2 offset:256
  s_waitcnt lgkmcnt(3)
  v_mfma_f32_32x32x16_bf16 v[24:39], a[20:23], v[44:47], v[24:39]
  ds_read_b128 v[44:47], v3 offset:256
  s_mov_b32 m0, s44
  s_add_u32 s44, s44, 1024
  s_waitcnt lgkmcnt(3)
  v_mfma_f32_32x32x16_bf16 v[24:39], a[24:27], v[48:51], v[24:39]
  ds_read_b128 v[48:51], v4 offset:256
  buffer_load_dwordx4 v11, s[12:15], s45 offen lds
  s_add_u32 s45, s45, 1024
  s_waitcnt lgkmcnt(3)
  v_mfma_f32_32x32x16_bf16 v[24:39], a[28:31], v[52:55], v[24:39]
  ds_read_b128 v[52:55], v5 offset:256
  s_waitcnt lgkmcnt(3)
  v_mfma_f32_32x32x16_bf16 v[24:39], a[32:35], v[40:43], v[24:39]
  ds_read_b128 v[40:43], v6 offset:256
  s_waitcnt lgkmcnt(3)
  v_mfma_f32_32x32x16_bf16 v[24:39], a[36:39], v[44:47], v[24:39]
  ds_read_b128 v[44:47], v7 offset:256
  s_mov_b32 m0, s44
  s_add_u32 s44, s44, 1024
  s_waitcnt lgkmcnt(3)
  v_mfma_f32_32x32x16_bf16 v[24:39], a[40:43], v[48:51], v[24:39]
  ds_read_b128 v[48:51], v8 offset:256
  buffer_load_dwordx4 v12, s[12:15], s45 offen lds
  s_add_u32 s45, s45, 1024
  s_waitcnt lgkmcnt(3)
  v_mfma_f32_32x32x16_bf16 v[24:39], a[44:47], v[52:55], v[24:39]
  ds_read_b128 v[52:55], v9 offset:256
  s_waitcnt lgkmcnt(3)
  v_mfma_f32_32x32x16_bf16 v[24:39], a[48:51], v[40:43], v[24:39]
  ds_read_b128 v[40:43], v2 offset:512
  s_waitcnt lgkmcnt(3)
  v_mfma_f32_32x32x16_bf16 v[24:39], a[52:55], v[44:47], v[24:39]
  ds_read_b128 v[44:47], v3 offset:512
  s_mov_b32 m0, s44
  s_add_u32 s44, s44, 1024
  s_waitcnt lgkmcnt(3)
  v_mfma_f32_32x32x16_bf16 v[24:39], a[56:59], v[48:51], v[24:39]
  ds_read_b128 v[48:51], v4 offset:512
  buffer_load_dwordx4 v13, s[12:15], s45 offen lds
  s_add_u32 s45, s45, 1024
  s_waitcnt lgkmcnt(3)
  v_mfma_f32_32x32x16_bf16 v[24:39], a[60:63], v[52:55], v[24:39]
  ds_read_b128 v[52:55], v5 offset:512
  s_waitcnt lgkmcnt(3)
  v_mfma_f32_32x32x16_bf16 v[24:39], a[64:67], v[40:43], v[24:39]
  ds_read_b128 v[40:43], v6 offset:512
  s_waitcnt lgkmcnt(3)
  v_mfma_f32_32x32x16_bf16 v[24:39], a[68:71], v[44:47], v[24:39]
  ds_read_b128 v[44:47], v7 offset:512
  s_mov_b32 m0, s44
  s_add_u32 s44, s44, 1024
  s_waitcnt lgkmcnt(3)
  v_mfma_f32_32x32x16_bf16 v[24:39], a[72:75], v[48:51], v[24:39]
  ds_read_b128 v[48:51], v8 offset:512
  buffer_load_dwordx4 v14, s[12:15], s45 offen lds
  s_add_u32 s45, s45, 1024
  s_waitcnt lgkmcnt(3)
  v_mfma_f32_32x32x16_bf16 v[24:39], a[76:79], v[52:55], v[24:39]
  ds_read_b128 v[52:55], v9 offset:512
  s_waitcnt lgkmcnt(3)
  v_mfma_f32_32x32x16_bf16 v[24:39], a[80:83], v[40:43], v[24:39]
  ds_read_b128 v[40:43], v2 offset:768
  s_waitcnt lgkmcnt(3)
  v_mfma_f32_32x32x16_bf16 v[24:39], a[84:87], v[44:47], v[24:39]
  ds_read_b128 v[44:47], v3 offset:768
  s_mov_b32 m0, s44
  s_add_u32 s44, s44, 1024
  s_waitcnt lgkmcnt(3)
  v_mfma_f32_32x32x16_bf16 v[24:39], a[88:91], v[48:51], v[24:39]
  ds_read_b128 v[48:51], v4 offset:768
  buffer_load_dwordx4 v15, s[12:15], s45 offen lds
  s_add_u32 s45, s45, 1024
  s_waitcnt lgkmcnt(3)
  v_mfma_f32_32x32x16_bf16 v[24:39], a[92:95], v[52:55], v[24:39]
  ds_read_b128 v[52:55], v5 offset:768
  s_waitcnt lgkmcnt(3)
  v_mfma_f32_32x32x16_bf16 v[24:39], a[96:99], v[40:43], v[24:39]
  ds_read_b128 v[40:43], v6 offset:768
  s_waitcnt lgkmcnt(3)
  v_mfma_f32_32x32x16_bf16 v[24:39], a[100:103], v[44:47], v[24:39]
  ds_read_b128 v[44:47], v7 offset:768
  s_mov_b32 m0, s44
  s_add_u32 s44, s44, 1024
  s_waitcnt lgkmcnt(3)
  v_mfma_f32_32x32x16_bf16 v[24:39], a[104:107], v[48:51], v[24:39]
  ds_read_b128 v[48:51], v8 offset:768
  buffer_load_dwordx4 v16, s[12:15], s45 offen lds
  s_add_u32 s45, s45, 1024
  s_waitcnt lgkmcnt(3)
  v_mfma_f32_32x32x16_bf16 v[24:39], a[108:111], v[52:55], v[24:39]
  ds_read_b128 v[52:55], v9 offset:768
  s_waitcnt lgkmcnt(3)
  v_mfma_f32_32x32x16_bf16 v[24:39], a[112:115], v[40:43], v[24:39]
  s_waitcnt lgkmcnt(2)
  v_mfma_f32_32x32x16_bf16 v[24:39], a[116:119], v[44:47], v[24:39]
  s_mov_b32 m0, s44
  s_add_u32 s44, s44, 1024
  s_waitcnt lgkmcnt(1)
  v_mfma_f32_32x32x16_bf16 v[24:39], a[120:123], v[48:51], v[24:39]
  buffer_load_dwordx4 v17, s[12:15], s45 offen lds
  s_add_u32 s45, s45, 1024
  s_waitcnt lgkmcnt(0)
  v_mfma_f32_32x32x16_bf16 v[24:39], a[124:127], v[52:55], v[24:39]
  s_add_u32 s29, s29, 32768
  s_cmp_ge_u32 s29, 98304
  s_mov_b32 s40, 32768
  s_cselect_b32 s40, 4294901760, s40
  s_cselect_b32 s41, 0, s29
  s_mov_b32 s29, s41
  v_add_u32 v2, s40, v2
  v_add_u32 v3, s40, v3
  v_add_u32 v4, s40, v4
  v_add_u32 v5, s40, v5
  v_add_u32 v6, s40, v6
  v_add_u32 v7, s40, v7
  v_add_u32 v8, s40, v8
  v_add_u32 v9, s40, v9
  s_nop 3
  v_cvt_pk_bf16_f32 v56, v24, v25
  v_cvt_pk_bf16_f32 v57, v26, v27
  v_cvt_pk_bf16_f32 v58, v28, v29
  v_cvt_pk_bf16_f32 v59, v30, v31
  v_cvt_pk_bf16_f32 v60, v32, v33
  v_cvt_pk_bf16_f32 v61, v34, v35
  v_cvt_pk_bf16_f32 v62, v36, v37
  v_cvt_pk_bf16_f32 v63, v38, v39
  s_mul_i32 s40, s24, s27
  s_add_u32 s40, s40, s26
  buffer_store_dwordx4 v[56:59], v18, s[8:11], s40 offen sc1
  buffer_store_dwordx4 v[60:63], v18, s[8:11], s40 offen offset:512 sc1
  s_add_u32 s24, s24, s25
  s_add_u32 s22, s22, 1
  s_cmp_lt_u32 s22, s23
  s_cbranch_scc1 GKQ_LOOP
  s_waitcnt vmcnt(0)
  s_barrier
  s_cmp_eq_u32 s21, 0
  s_cbranch_scc0 GKQ_END
  v_mov_b32 v20, s23
  s_mov_b64 exec, 1
  buffer_store_dword v20, v19, s[8:11], s28 offen sc1
  s_mov_b64 exec, -1
  s_waitcnt vmcnt(0)
GKQ_END:
  s_branch G_DONE
G_VROLE:
  s_mov_b32 s16, s72
  s_and_b32 s17, s73, 0xffff
  s_mov_b32 s18, 0x400000
  s_mov_b32 s19, 0x20000
  s_add_u32 s26, s26, 16777216
  s_lshl_b32 s40, s21, 11
  s_add_u32 s26, s26, s40
  v_bfe_u32 v20, v0, 4, 1
  v_lshlrev_b32 v18, 10, v20
  v_bfe_u32 v20, v0, 5, 1
  v_lshl_add_u32 v18, v20, 8, v18
  v_bfe_u32 v20, v0, 0, 4
  v_lshl_add_u32 v18, v20, 4, v18
  v_lshrrev_b32 v20, 2, v0
  v_mul_lo_u32 v64, v20, s32
  v_and_b32 v20, 3, v0
  v_lshl_add_u32 v64, v20, 4, v64
  s_lshl_b32 s40, s21, 13
  s_add_u32 s40, s40, 98304
  v_bfe_u32 v20, v0, 4, 2
  v_lshlrev_b32 v65, 8, v20
  v_bfe_u32 v20, v0, 1, 1
  v_lshl_add_u32 v65, v20, 7, v65
  v_bfe_u32 v20, v0, 2, 2
  v_lshl_add_u32 v65, v20, 5, v65
  v_bfe_u32 v20, v0, 0, 1
  v_lshl_add_u32 v65, v20, 4, v65
  v_add_u32 v65, s40, v65
  v_bfe_u32 v20, v0, 5, 1
  v_lshlrev_b32 v66, 9, v20
  v_bfe_u32 v20, v0, 4, 1
  v_lshl_add_u32 v66, v20, 7, v66
  v_bfe_u32 v20, v0, 2, 2
  v_lshl_add_u32 v66, v20, 5, v66
  v_bfe_u32 v20, v0, 0, 2
  v_lshl_add_u32 v66, v20, 3, v66
  v_add_u32 v66, s40, v66
  s_lshl_b32 s41, s32, 4
  s_mov_b32 s40, s33
  buffer_load_dwordx4 a[0:3], v64, s[16:19], s40 offen
  s_add_u32 s40, s40, s41
  buffer_load_dwordx4 a[4:7], v64, s[16:19], s40 offen
  s_add_u32 s40, s40, s41
  buffer_load_dwordx4 a[8:11], v64, s[16:19], s40 offen
  s_add_u32 s40, s40, s41
  buffer_load_dwordx4 a[12:15], v64, s[16:19], s40 offen
  s_add_u32 s40, s40, s41
  buffer_load_dwordx4 a[16:19], v64, s[16:19], s40 offen
  s_add_u32 s40, s40, s41
  buffer_load_dwordx4 a[20:23], v64, s[16:19], s40 offen
  s_add_u32 s40, s40, s41
  buffer_load_dwordx4 a[24:27], v64, s[16:19], s40 offen
  s_add_u32 s40, s40, s41
  buffer_load_dwordx4 a[28:31], v64, s[16:19], s40 offen
  s_add_u32 s40, s40, s41
  buffer_load_dwordx4 a[32:35], v64, s[16:19], s40 offen
  s_add_u32 s40, s40, s41
  buffer_load_dwordx4 a[36:39], v64, s[16:19], s40 offen
  s_add_u32 s40, s40, s41
  buffer_load_dwordx4 a[40:43], v64, s[16:19], s40 offen
  s_add_u32 s40, s40, s41
  buffer_load_dwordx4 a[44:47], v64, s[16:19], s40 offen
  s_add_u32 s40, s40, s41
  buffer_load_dwordx4 a[48:51], v64, s[16:19], s40 offen
  s_add_u32 s40, s40, s41
  buffer_load_dwordx4 a[52:55], v64, s[16:19], s40 offen
  s_add_u32 s40, s40, s41
  buffer_load_dwordx4 a[56:59], v64, s[16:19], s40 offen
  s_add_u32 s40, s40, s41
  buffer_load_dwordx4 a[60:63], v64, s[16:19], s40 offen
  s_add_u32 s40, s40, s41
  buffer_load_dwordx4 a[64:67], v64, s[16:19], s40 offen
  s_add_u32 s40, s40, s41
  buffer_load_dwordx4 a[68:71], v64, s[16:19], s40 offen
  s_add_u32 s40, s40, s41
  buffer_load_dwordx4 a[72:75], v64, s[16:19], s40 offen
  s_add_u32 s40, s40, s41
  buffer_load_dwordx4 a[76:79], v64, s[16:19], s40 offen
  s_add_u32 s40, s40, s41
  buffer_load_dwordx4 a[80:83], v64, s[16:19], s40 offen
  s_add_u32 s40, s40, s41
  buffer_load_dwordx4 a[84:87], v64, s[16:19], s40 offen
  s_add_u32 s40, s40, s41
  buffer_load_dwordx4 a[88:91], v64, s[16:19], s40 offen
  s_add_u32 s40, s40, s41
  buffer_load_dwordx4 a[92:95], v64, s[16:19], s40 offen
  s_add_u32 s40, s40, s41
  buffer_load_dwordx4 a[96:99], v64, s[16:19], s40 offen
  s_add_u32 s40, s40, s41
  buffer_load_dwordx4 a[100:103], v64, s[16:19], s40 offen
  s_add_u32 s40, s40, s41
  buffer_load_dwordx4 a[104:107], v64, s[16:19], s40 offen
  s_add_u32 s40, s40, s41
  buffer_load_dwordx4 a[108:111], v64, s[16:19], s40 offen
  s_add_u32 s40, s40, s41
  buffer_load_dwordx4 a[112:115], v64, s[16:19], s40 offen
  s_add_u32 s40, s40, s41
  buffer_load_dwordx4 a[116:119], v64, s[16:19], s40 offen
  s_add_u32 s40, s40, s41
  buffer_load_dwordx4 a[120:123], v64, s[16:19], s40 offen
  s_add_u32 s40, s40, s41
  buffer_load_dwordx4 a[124:127], v64, s[16:19], s40 offen
  s_add_u32 s40, s40, s41
  s_lshl_b32 s40, s20, 10
  s_lshl_b32 s41, s21, 19
  s_lshl_b32 s41, s21, 15
  s_add_u32 s40, s40, s41
  buffer_load_dwordx4 v[72:75], v1, s[12:15], s40 offen
  s_add_u32 s40, s40, 131072
  buffer_load_dwordx4 v[76:79], v1, s[12:15], s40 offen
  s_add_u32 s40, s40, 131072
  buffer_load_dwordx4 v[80:83], v1, s[12:15], s40 offen
  s_add_u32 s40, s40, 131072
  buffer_load_dwordx4 v[84:87], v1, s[12:15], s40 offen
  s_add_u32 s40, s40, 131072
  buffer_load_dwordx4 v[72:75], v1, s[12:15], s40 offen
  s_add_u32 s40, s40, 131072
  buffer_load_dwordx4 v[76:79], v1, s[12:15], s40 offen
  s_add_u32 s40, s40, 131072
  buffer_load_dwordx4 v[80:83], v1, s[12:15], s40 offen
  s_add_u32 s40, s40, 131072
  buffer_load_dwordx4 v[84:87], v1, s[12:15], s40 offen
  s_add_u32 s40, s40, 131072
  buffer_load_dwordx4 v[72:75], v1, s[12:15], s40 offen
  s_add_u32 s40, s40, 131072
  buffer_load_dwordx4 v[76:79], v1, s[12:15], s40 offen
  s_add_u32 s40, s40, 131072
  buffer_load_dwordx4 v[80:83], v1, s[12:15], s40 offen
  s_add_u32 s40, s40, 131072
  buffer_load_dwordx4 v[84:87], v1, s[12:15], s40 offen
  s_add_u32 s40, s40, 131072
  buffer_load_dwordx4 v[72:75], v1, s[12:15], s40 offen
  s_add_u32 s40, s40, 131072
  buffer_load_dwordx4 v[76:79], v1, s[12:15], s40 offen
  s_add_u32 s40, s40, 131072
  buffer_load_dwordx4 v[80:83], v1, s[12:15], s40 offen
  s_add_u32 s40, s40, 131072
  buffer_load_dwordx4 v[84:87], v1, s[12:15], s40 offen
  s_add_u32 s40, s40, 131072
  s_waitcnt vmcnt(40)
  ds_write_b128 v65, a[0:3] offset:0
  ds_write_b128 v65, a[4:7] offset:1024
  ds_write_b128 v65, a[8:11] offset:2048
  ds_write_b128 v65, a[12:15] offset:3072
  ds_write_b128 v65, a[16:19] offset:4096
  ds_write_b128 v65, a[20:23] offset:5120
  ds_write_b128 v65, a[24:27] offset:6144
  ds_write_b128 v65, a[28:31] offset:7168
  s_waitcnt lgkmcnt(0)
  ds_read_b64_tr_b16 a[0:1], v66 offset:0
  ds_read_b64_tr_b16 a[2:3], v66 offset:256
  ds_read_b64_tr_b16 a[4:5], v66 offset:1024
  ds_read_b64_tr_b16 a[6:7], v66 offset:1280
  ds_read_b64_tr_b16 a[8:9], v66 offset:2048
  ds_read_b64_tr_b16 a[10:11], v66 offset:2304
  ds_read_b64_tr_b16 a[12:13], v66 offset:3072
  ds_read_b64_tr_b16 a[14:15], v66 offset:3328
  ds_read_b64_tr_b16 a[16:17], v66 offset:4096
  ds_read_b64_tr_b16 a[18:19], v66 offset:4352
  ds_read_b64_tr_b16 a[20:21], v66 offset:5120
  ds_read_b64_tr_b16 a[22:23], v66 offset:5376
  ds_read_b64_tr_b16 a[24:25], v66 offset:6144
  ds_read_b64_tr_b16 a[26:27], v66 offset:6400
  ds_read_b64_tr_b16 a[28:29], v66 offset:7168
  ds_read_b64_tr_b16 a[30:31], v66 offset:7424
  s_waitcnt lgkmcnt(0)
  s_waitcnt vmcnt(32)
  ds_write_b128 v65, a[32:35] offset:0
  ds_write_b128 v65, a[36:39] offset:1024
  ds_write_b128 v65, a[40:43] offset:2048
  ds_write_b128 v65, a[44:47] offset:3072
  ds_write_b128 v65, a[48:51] offset:4096
  ds_write_b128 v65, a[52:55] offset:5120
  ds_write_b128 v65, a[56:59] offset:6144
  ds_write_b128 v65, a[60:63] offset:7168
  s_waitcnt lgkmcnt(0)
  ds_read_b64_tr_b16 a[32:33], v66 offset:0
  ds_read_b64_tr_b16 a[34:35], v66 offset:256
  ds_read_b64_tr_b16 a[36:37], v66 offset:1024
  ds_read_b64_tr_b16 a[38:39], v66 offset:1280
  ds_read_b64_tr_b16 a[40:41], v66 offset:2048
  ds_read_b64_tr_b16 a[42:43], v66 offset:2304
  ds_read_b64_tr_b16 a[44:45], v66 offset:3072
  ds_read_b64_tr_b16 a[46:47], v66 offset:3328
  ds_read_b64_tr_b16 a[48:49], v66 offset:4096
  ds_read_b64_tr_b16 a[50:51], v66 offset:4352
  ds_read_b64_tr_b16 a[52:53], v66 offset:5120
  ds_read_b64_tr_b16 a[54:55], v66 offset:5376
  ds_read_b64_tr_b16 a[56:57], v66 offset:6144
  ds_read_b64_tr_b16 a[58:59], v66 offset:6400
  ds_read_b64_tr_b16 a[60:61], v66 offset:7168
  ds_read_b64_tr_b16 a[62:63], v66 offset:7424
  s_waitcnt lgkmcnt(0)
  s_waitcnt vmcnt(24)
  ds_write_b128 v65, a[64:67] offset:0
  ds_write_b128 v65, a[68:71] offset:1024
  ds_write_b128 v65, a[72:75] offset:2048
  ds_write_b128 v65, a[76:79] offset:3072
  ds_write_b128 v65, a[80:83] offset:4096
  ds_write_b128 v65, a[84:87] offset:5120
  ds_write_b128 v65, a[88:91] offset:6144
  ds_write_b128 v65, a[92:95] offset:7168
  s_waitcnt lgkmcnt(0)
  ds_read_b64_tr_b16 a[64:65], v66 offset:0
  ds_read_b64_tr_b16 a[66:67], v66 offset:256
  ds_read_b64_tr_b16 a[68:69], v66 offset:1024
  ds_read_b64_tr_b16 a[70:71], v66 offset:1280
  ds_read_b64_tr_b16 a[72:73], v66 offset:2048
  ds_read_b64_tr_b16 a[74:75], v66 offset:2304
  ds_read_b64_tr_b16 a[76:77], v66 offset:3072
  ds_read_b64_tr_b16 a[78:79], v66 offset:3328
  ds_read_b64_tr_b16 a[80:81], v66 offset:4096
  ds_read_b64_tr_b16 a[82:83], v66 offset:4352
  ds_read_b64_tr_b16 a[84:85], v66 offset:5120
  ds_read_b64_tr_b16 a[86:87], v66 offset:5376
  ds_read_b64_tr_b16 a[88:89], v66 offset:6144
  ds_read_b64_tr_b16 a[90:91], v66 offset:6400
  ds_read_b64_tr_b16 a[92:93], v66 offset:7168
  ds_read_b64_tr_b16 a[94:95], v66 offset:7424
  s_waitcnt lgkmcnt(0)
  s_waitcnt vmcnt(16)
  ds_write_b128 v65, a[96:99] offset:0
  ds_write_b128 v65, a[100:103] offset:1024
  ds_write_b128 v65, a[104:107] offset:2048
  ds_write_b128 v65, a[108:111] offset:3072
  ds_write_b128 v65, a[112:115] offset:4096
  ds_write_b128 v65, a[116:119] offset:5120
  ds_write_b128 v65, a[120:123] offset:6144
  ds_write_b128 v65, a[124:127] offset:7168
  s_waitcnt lgkmcnt(0)
  ds_read_b64_tr_b16 a[96:97], v66 offset:0
  ds_read_b64_tr_b16 a[98:99], v66 offset:256
  ds_read_b64_tr_b16 a[100:101], v66 offset:1024
  ds_read_b64_tr_b16 a[102:103], v66 offset:1280
  ds_read_b64_tr_b16 a[104:105], v66 offset:2048
  ds_read_b64_tr_b16 a[106:107], v66 offset:2304
  ds_read_b64_tr_b16 a[108:109], v66 offset:3072
  ds_read_b64_tr_b16 a[110:111], v66 offset:3328
  ds_read_b64_tr_b16 a[112:113], v66 offset:4096
  ds_read_b64_tr_b16 a[114:115], v66 offset:4352
  ds_read_b64_tr_b16 a[116:117], v66 offset:5120
  ds_read_b64_tr_b16 a[118:119], v66 offset:5376
  ds_read_b64_tr_b16 a[120:121], v66 offset:6144
  ds_read_b64_tr_b16 a[122:123], v66 offset:6400
  ds_read_b64_tr_b16 a[124:125], v66 offset:7168
  ds_read_b64_tr_b16 a[126:127], v66 offset:7424
  s_waitcnt lgkmcnt(0)
  s_cmp_eq_u32 s63, 0
  s_cbranch_scc0 H2_SKIP
  s_cmp_eq_u32 s21, 0
  s_cbranch_scc0 H2_NOSIG
  s_mov_b64 exec, 1
  v_mov_b32 v23, 1
  v_mov_b32 v22, 36
  buffer_atomic_add v23, v22, s[56:59], 0 offen
  s_mov_b64 exec, -1
H2_NOSIG:
H2_SKIP:
  s_mov_b32 s29, 0
  s_lshl_b32 s31, s24, 15
  s_mov_b32 s30, 0
  s_lshl_b32 s40, s21, 13
  s_add_u32 s41, s40, s31
  s_add_u32 s40, s40, s30
  s_mov_b32 m0, s40
  s_add_u32 s40, s40, 1024
  buffer_load_dwordx4 v10, s[12:15], s41 offen lds
  s_add_u32 s41, s41, 1024
  s_mov_b32 m0, s40
  s_add_u32 s40, s40, 1024
  buffer_load_dwordx4 v11, s[12:15], s41 offen lds
  s_add_u32 s41, s41, 1024
  s_mov_b32 m0, s40
  s_add_u32 s40, s40, 1024
  buffer_load_dwordx4 v12, s[12:15], s41 offen lds
  s_add_u32 s41, s41, 1024
  s_mov_b32 m0, s40
  s_add_u32 s40, s40, 1024
  buffer_load_dwordx4 v13, s[12:15], s41 offen lds
  s_add_u32 s41, s41, 1024
  s_mov_b32 m0, s40
  s_add_u32 s40, s40, 1024
  buffer_load_dwordx4 v14, s[12:15], s41 offen lds
  s_add_u32 s41, s41, 1024
  s_mov_b32 m0, s40
  s_add_u32 s40, s40, 1024
  buffer_load_dwordx4 v15, s[12:15], s41 offen lds
  s_add_u32 s41, s41, 1024
  s_mov_b32 m0, s40
  s_add_u32 s40, s40, 1024
  buffer_load_dwordx4 v16, s[12:15], s41 offen lds
  s_add_u32 s41, s41, 1024
  s_mov_b32 m0, s40
  s_nop 0
  buffer_load_dwordx4 v17, s[12:15], s41 offen lds
  s_lshl_b32 s42, s25, 15
  s_add_u32 s31, s31, s42
  s_mov_b32 s30, 32768
  s_lshl_b32 s40, s21, 13
  s_add_u32 s41, s40, s31
  s_add_u32 s40, s40, s30
  s_mov_b32 m0, s40
  s_add_u32 s40, s40, 1024
  buffer_load_dwordx4 v10, s[12:15], s41 offen lds
  s_add_u32 s41, s41, 1024
  s_mov_b32 m0, s40
  s_add_u32 s40, s40, 1024
  buffer_load_dwordx4 v11, s[12:15], s41 offen lds
  s_add_u32 s41, s41, 1024
  s_mov_b32 m0, s40
  s_add_u32 s40, s40, 1024
  buffer_load_dwordx4 v12, s[12:15], s41 offen lds
  s_add_u32 s41, s41, 1024
  s_mov_b32 m0, s40
  s_add_u32 s40, s40, 1024
  buffer_load_dwordx4 v13, s[12:15], s41 offen lds
  s_add_u32 s41, s41, 1024
  s_mov_b32 m0, s40
  s_add_u32 s40, s40, 1024
  buffer_load_dwordx4 v14, s[12:15], s41 offen lds
  s_add_u32 s41, s41, 1024
  s_mov_b32 m0, s40
  s_add_u32 s40, s40, 1024
  buffer_load_dwordx4 v15, s[12:15], s41 offen lds
  s_add_u32 s41, s41, 1024
  s_mov_b32 m0, s40
  s_add_u32 s40, s40, 1024
  buffer_load_dwordx4 v16, s[12:15], s41 offen lds
  s_add_u32 s41, s41, 1024
  s_mov_b32 m0, s40
  s_nop 0
  buffer_load_dwordx4 v17, s[12:15], s41 offen lds
  v_mov_b32 v21, 0x40000000
  buffer_store_dword v21, v21, s[8:11], 0 offen
  buffer_store_dword v21, v21, s[8:11], 0 offen
  s_mov_b32 s22, 0
  s_waitcnt vmcnt(10)
  s_branch GV_ENTER
GV_LOOP:
  s_waitcnt vmcnt(13)
GV_ENTER:
  s_barrier
  s_max_u32 s40, s22, 2
  s_sub_u32 s40, s40, 2
  v_mov_b32 v20, s40
  s_mov_b64 exec, 1
  buffer_store_dword v20, v19, s[8:11], s28 offen sc1
  s_mov_b64 exec, -1
  s_lshl_b32 s42, s25, 15
  s_add_u32 s31, s31, s42
  s_add_u32 s30, s30, 32768
  s_cmp_ge_u32 s30, 98304
  s_cselect_b32 s42, 98304, 0
  s_sub_u32 s30, s30, s42
  s_lshl_b32 s44, s21, 13
  s_add_u32 s45, s44, s31
  s_add_u32 s44, s44, s30
  ds_read_b128 v[40:43], v2 offset:0
  ds_read_b128 v[44:47], v3 offset:0
  ds_read_b128 v[48:51], v4 offset:0
  ds_read_b128 v[52:55], v5 offset:0
  s_waitcnt lgkmcnt(3)
  v_mfma_f32_32x32x16_bf16 v[24:39], v[40:43], a[0:3], 0
  ds_read_b128 v[40:43], v6 offset:0
  s_waitcnt lgkmcnt(3)
  v_mfma_f32_32x32x16_bf16 v[24:39], v[44:47], a[4:7], v[24:39]
  ds_read_b128 v[44:47], v7 offset:0
  s_mov_b32 m0, s44
  s_add_u32 s44, s44, 1024
  s_waitcnt lgkmcnt(3)
  v_mfma_f32_32x32x16_bf16 v[24:39], v[48:51], a[8:11], v[24:39]
  ds_read_b128 v[48:51], v8 offset:0
  buffer_load_dwordx4 v10, s[12:15], s45 offen lds
  s_add_u32 s45, s45, 1024
  s_waitcnt lgkmcnt(3)
  v_mfma_f32_32x32x16_bf16 v[24:39], v[52:55], a[12:15], v[24:39]
  ds_read_b128 v[52:55], v9 offset:0
  s_waitcnt lgkmcnt(3)
  v_mfma_f32_32x32x16_bf16 v[24:39], v[40:43], a[16:19], v[24:39]
  ds_read_b128 v[40:43], v2 offset:256
  s_waitcnt lgkmcnt(3)
  v_mfma_f32_32x32x16_bf16 v[24:39], v[44:47], a[20:23], v[24:39]
  ds_read_b128 v[44:47], v3 offset:256
  s_mov_b32 m0, s44
  s_add_u32 s44, s44, 1024
  s_waitcnt lgkmcnt(3)
  v_mfma_f32_32x32x16_bf16 v[24:39], v[48:51], a[24:27], v[24:39]
  ds_read_b128 v[48:51], v4 offset:256
  buffer_load_dwordx4 v11, s[12:15], s45 offen lds
  s_add_u32 s45, s45, 1024
  s_waitcnt lgkmcnt(3)
  v_mfma_f32_32x32x16_bf16 v[24:39], v[52:55], a[28:31], v[24:39]
  ds_read_b128 v[52:55], v5 offset:256
  s_waitcnt lgkmcnt(3)
  v_mfma_f32_32x32x16_bf16 v[24:39], v[40:43], a[32:35], v[24:39]
  ds_read_b128 v[40:43], v6 offset:256
  s_waitcnt lgkmcnt(3)
  v_mfma_f32_32x32x16_bf16 v[24:39], v[44:47], a[36:39], v[24:39]
  ds_read_b128 v[44:47], v7 offset:256
  s_mov_b32 m0, s44
  s_add_u32 s44, s44, 1024
  s_waitcnt lgkmcnt(3)
  v_mfma_f32_32x32x16_bf16 v[24:39], v[48:51], a[40:43], v[24:39]
  ds_read_b128 v[48:51], v8 offset:256
  buffer_load_dwordx4 v12, s[12:15], s45 offen lds
  s_add_u32 s45, s45, 1024
  s_waitcnt lgkmcnt(3)
  v_mfma_f32_32x32x16_bf16 v[24:39], v[52:55], a[44:47], v[24:39]
  ds_read_b128 v[52:55], v9 offset:256
  s_waitcnt lgkmcnt(3)
  v_mfma_f32_32x32x16_bf16 v[24:39], v[40:43], a[48:51], v[24:39]
  ds_read_b128 v[40:43], v2 offset:512
  s_waitcnt lgkmcnt(3)
  v_mfma_f32_32x32x16_bf16 v[24:39], v[44:47], a[52:55], v[24:39]
  ds_read_b128 v[44:47], v3 offset:512
  s_mov_b32 m0, s44
  s_add_u32 s44, s44, 1024
  s_waitcnt lgkmcnt(3)
  v_mfma_f32_32x32x16_bf16 v[24:39], v[48:51], a[56:59], v[24:39]
  ds_read_b128 v[48:51], v4 offset:512
  buffer_load_dwordx4 v13, s[12:15], s45 offen lds
  s_add_u32 s45, s45, 1024
  s_waitcnt lgkmcnt(3)
  v_mfma_f32_32x32x16_bf16 v[24:39], v[52:55], a[60:63], v[24:39]
  ds_read_b128 v[52:55], v5 offset:512
  s_waitcnt lgkmcnt(3)
  v_mfma_f32_32x32x16_bf16 v[24:39], v[40:43], a[64:67], v[24:39]
  ds_read_b128 v[40:43], v6 offset:512
  s_waitcnt lgkmcnt(3)
  v_mfma_f32_32x32x16_bf16 v[24:39], v[44:47], a[68:71], v[24:39]
  ds_read_b128 v[44:47], v7 offset:512
  s_mov_b32 m0, s44
  s_add_u32 s44, s44, 1024
  s_waitcnt lgkmcnt(3)
  v_mfma_f32_32x32x16_bf16 v[24:39], v[48:51], a[72:75], v[24:39]
  ds_read_b128 v[48:51], v8 offset:512
  buffer_load_dwordx4 v14, s[12:15], s45 offen lds
  s_add_u32 s45, s45, 1024
  s_waitcnt lgkmcnt(3)
  v_mfma_f32_32x32x16_bf16 v[24:39], v[52:55], a[76:79], v[24:39]
  ds_read_b128 v[52:55], v9 offset:512
  s_waitcnt lgkmcnt(3)
  v_mfma_f32_32x32x16_bf16 v[24:39], v[40:43], a[80:83], v[24:39]
  ds_read_b128 v[40:43], v2 offset:768
  s_waitcnt lgkmcnt(3)
  v_mfma_f32_32x32x16_bf16 v[24:39], v[44:47], a[84:87], v[24:39]
  ds_read_b128 v[44:47], v3 offset:768
  s_mov_b32 m0, s44
  s_add_u32 s44, s44, 1024
  s_waitcnt lgkmcnt(3)
  v_mfma_f32_32x32x16_bf16 v[24:39], v[48:51], a[88:91], v[24:39]
  ds_read_b128 v[48:51], v4 offset:768
  buffer_load_dwordx4 v15, s[12:15], s45 offen lds
  s_add_u32 s45, s45, 1024
  s_waitcnt lgkmcnt(3)
  v_mfma_f32_32x32x16_bf16 v[24:39], v[52:55], a[92:95], v[24:39]
  ds_read_b128 v[52:55], v5 offset:768
  s_waitcnt lgkmcnt(3)
  v_mfma_f32_32x32x16_bf16 v[24:39], v[40:43], a[96:99], v[24:39]
  ds_read_b128 v[40:43], v6 offset:768
  s_waitcnt lgkmcnt(3)
  v_mfma_f32_32x32x16_bf16 v[24:39], v[44:47], a[100:103], v[24:39]
  ds_read_b128 v[44:47], v7 offset:768
  s_mov_b32 m0, s44
  s_add_u32 s44, s44, 1024
  s_waitcnt lgkmcnt(3)
  v_mfma_f32_32x32x16_bf16 v[24:39], v[48:51], a[104:107], v[24:39]
  ds_read_b128 v[48:51], v8 offset:768
  buffer_load_dwordx4 v16, s[12:15], s45 offen lds
  s_add_u32 s45, s45, 1024
  s_waitcnt lgkmcnt(3)
  v_mfma_f32_32x32x16_bf16 v[24:39], v[52:55], a[108:111], v[24:39]
  ds_read_b128 v[52:55], v9 offset:768
  s_waitcnt lgkmcnt(3)
  v_mfma_f32_32x32x16_bf16 v[24:39], v[40:43], a[112:115], v[24:39]
  s_waitcnt lgkmcnt(2)
  v_mfma_f32_32x32x16_bf16 v[24:39], v[44:47], a[116:119], v[24:39]
  s_mov_b32 m0, s44
  s_add_u32 s44, s44, 1024
  s_waitcnt lgkmcnt(1)
  v_mfma_f32_32x32x16_bf16 v[24:39], v[48:51], a[120:123], v[24:39]
  buffer_load_dwordx4 v17, s[12:15], s45 offen lds
  s_add_u32 s45, s45, 1024
  s_waitcnt lgkmcnt(0)
  v_mfma_f32_32x32x16_bf16 v[24:39], v[52:55], a[124:127], v[24:39]
  s_add_u32 s29, s29, 32768
  s_cmp_ge_u32 s29, 98304
  s_mov_b32 s40, 32768
  s_cselect_b32 s40, 4294901760, s40
  s_cselect_b32 s41, 0, s29
  s_mov_b32 s29, s41
  v_add_u32 v2, s40, v2
  v_add_u32 v3, s40, v3
  v_add_u32 v4, s40, v4
  v_add_u32 v5, s40, v5
  v_add_u32 v6, s40, v6
  v_add_u32 v7, s40, v7
  v_add_u32 v8, s40, v8
  v_add_u32 v9, s40, v9
  s_nop 3
  v_cvt_pk_bf16_f32 v56, v24, v25
  v_cvt_pk_bf16_f32 v57, v26, v27
  v_cvt_pk_bf16_f32 v58, v28, v29
  v_cvt_pk_bf16_f32 v59, v30, v31
  v_cvt_pk_bf16_f32 v60, v32, v33
  v_cvt_pk_bf16_f32 v61, v34, v35
  v_cvt_pk_bf16_f32 v62, v36, v37
  v_cvt_pk_bf16_f32 v63, v38, v39
  s_mul_i32 s40, s24, s27
  s_add_u32 s40, s40, s26
  buffer_store_dwordx4 v[56:59], v18, s[8:11], s40 offen sc1
  buffer_store_dwordx4 v[60:63], v18, s[8:11], s40 offen offset:512 sc1
  s_add_u32 s24, s24, s25
  s_add_u32 s22, s22, 1
  s_cmp_lt_u32 s22, s23
  s_cbranch_scc1 GV_LOOP
  s_waitcnt vmcnt(0)
  s_barrier
  s_cmp_eq_u32 s21, 0
  s_cbranch_scc0 GV_END
  v_mov_b32 v20, s23
  s_mov_b64 exec, 1
  buffer_store_dword v20, v19, s[8:11], s28 offen sc1
  s_mov_b64 exec, -1
  s_waitcnt vmcnt(0)
GV_END:
  s_branch G_DONE
G_BROLE:
  s_cmp_lt_u32 s94, 208
  s_cbranch_scc0 G_SMROLE
  s_sub_u32 s44, s94, 192
  s_and_b32 s45, s44, 3
  s_lshr_b32 s44, s44, 2
  s_lshl_b32 s24, s44, 4
  s_mov_b32 s25, 1
  s_mov_b32 s23, 16
  s_mov_b32 s32, 1024
  s_lshl_b32 s33, s45, 8
  s_lshl_b32 s40, s21, 6
  s_add_u32 s33, s33, s40
  s_mov_b32 s27, 32768
  s_lshl_b32 s26, s45, 13
  s_lshl_b32 s40, s21, 11
  s_add_u32 s26, s26, s40
  s_add_u32 s26, s26, 62914560
  s_mov_b32 s16, s76
  s_and_b32 s17, s77, 0xffff
  s_mov_b32 s18, 0x80000
  s_mov_b32 s19, 0x20000
  v_lshrrev_b32 v20, 2, v0
  v_mul_lo_u32 v64, v20, s32
  v_and_b32 v20, 3, v0
  v_lshl_add_u32 v64, v20, 4, v64
  s_lshl_b32 s40, s21, 13
  s_add_u32 s40, s40, 98304
  v_bfe_u32 v20, v0, 4, 2
  v_lshlrev_b32 v65, 8, v20
  v_bfe_u32 v20, v0, 1, 1
  v_lshl_add_u32 v65, v20, 7, v65
  v_bfe_u32 v20, v0, 2, 2
  v_lshl_add_u32 v65, v20, 5, v65
  v_bfe_u32 v20, v0, 0, 1
  v_lshl_add_u32 v65, v20, 4, v65
  v_add_u32 v65, s40, v65
  v_bfe_u32 v20, v0, 5, 1
  v_lshlrev_b32 v66, 9, v20
  v_bfe_u32 v20, v0, 4, 1
  v_lshl_add_u32 v66, v20, 7, v66
  v_bfe_u32 v20, v0, 2, 2
  v_lshl_add_u32 v66, v20, 5, v66
  v_bfe_u32 v20, v0, 0, 2
  v_lshl_add_u32 v66, v20, 3, v66
  v_add_u32 v66, s40, v66
  s_lshl_b32 s41, s32, 4
  s_mov_b32 s40, s33
  buffer_load_dwordx4 a[0:3], v64, s[16:19], s40 offen
  s_add_u32 s40, s40, s41
  buffer_load_dwordx4 a[4:7], v64, s[16:19], s40 offen
  s_add_u32 s40, s40, s41
  buffer_load_dwordx4 a[8:11], v64, s[16:19], s40 offen
  s_add_u32 s40, s40, s41
  buffer_load_dwordx4 a[12:15], v64, s[16:19], s40 offen
  s_add_u32 s40, s40, s41
  buffer_load_dwordx4 a[16:19], v64, s[16:19], s40 offen
  s_add_u32 s40, s40, s41
  buffer_load_dwordx4 a[20:23], v64, s[16:19], s40 offen
  s_add_u32 s40, s40, s41
  buffer_load_dwordx4 a[24:27], v64, s[16:19], s40 offen
  s_add_u32 s40, s40, s41
  buffer_load_dwordx4 a[28:31], v64, s[16:19], s40 offen
  s_add_u32 s40, s40, s41
  buffer_load_dwordx4 a[32:35], v64, s[16:19], s40 offen
  s_add_u32 s40, s40, s41
  buffer_load_dwordx4 a[36:39], v64, s[16:19], s40 offen
  s_add_u32 s40, s40, s41
  buffer_load_dwordx4 a[40:43], v64, s[16:19], s40 offen
  s_add_u32 s40, s40, s41
  buffer_load_dwordx4 a[44:47], v64, s[16:19], s40 offen
  s_add_u32 s40, s40, s41
  buffer_load_dwordx4 a[48:51], v64, s[16:19], s40 offen
  s_add_u32 s40, s40, s41
  buffer_load_dwordx4 a[52:55], v64, s[16:19], s40 offen
  s_add_u32 s40, s40, s41
  buffer_load_dwordx4 a[56:59], v64, s[16:19], s40 offen
  s_add_u32 s40, s40, s41
  buffer_load_dwordx4 a[60:63], v64, s[16:19], s40 offen
  s_add_u32 s40, s40, s41
  buffer_load_dwordx4 a[64:67], v64, s[16:19], s40 offen
  s_add_u32 s40, s40, s41
  buffer_load_dwordx4 a[68:71], v64, s[16:19], s40 offen
  s_add_u32 s40, s40, s41
  buffer_load_dwordx4 a[72:75], v64, s[16:19], s40 offen
  s_add_u32 s40, s40, s41
  buffer_load_dwordx4 a[76:79], v64, s[16:19], s40 offen
  s_add_u32 s40, s40, s41
  buffer_load_dwordx4 a[80:83], v64, s[16:19], s40 offen
  s_add_u32 s40, s40, s41
  buffer_load_dwordx4 a[84:87], v64, s[16:19], s40 offen
  s_add_u32 s40, s40, s41
  buffer_load_dwordx4 a[88:91], v64, s[16:19], s40 offen
  s_add_u32 s40, s40, s41
  buffer_load_dwordx4 a[92:95], v64, s[16:19], s40 offen
  s_add_u32 s40, s40, s41
  buffer_load_dwordx4 a[96:99], v64, s[16:19], s40 offen
  s_add_u32 s40, s40, s41
  buffer_load_dwordx4 a[100:103], v64, s[16:19], s40 offen
  s_add_u32 s40, s40, s41
  buffer_load_dwordx4 a[104:107], v64, s[16:19], s40 offen
  s_add_u32 s40, s40, s41
  buffer_load_dwordx4 a[108:111], v64, s[16:19], s40 offen
  s_add_u32 s40, s40, s41
  buffer_load_dwordx4 a[112:115], v64, s[16:19], s40 offen
  s_add_u32 s40, s40, s41
  buffer_load_dwordx4 a[116:119], v64, s[16:19], s40 offen
  s_add_u32 s40, s40, s41
  buffer_load_dwordx4 a[120:123], v64, s[16:19], s40 offen
  s_add_u32 s40, s40, s41
  buffer_load_dwordx4 a[124:127], v64, s[16:19], s40 offen
  s_add_u32 s40, s40, s41
  s_lshl_b32 s40, s20, 10
  s_lshl_b32 s41, s21, 19
  s_lshl_b32 s41, s21, 15
  s_add_u32 s40, s40, s41
  buffer_load_dwordx4 v[72:75], v1, s[12:15], s40 offen
  s_add_u32 s40, s40, 131072
  buffer_load_dwordx4 v[76:79], v1, s[12:15], s40 offen
  s_add_u32 s40, s40, 131072
  buffer_load_dwordx4 v[80:83], v1, s[12:15], s40 offen
  s_add_u32 s40, s40, 131072
  buffer_load_dwordx4 v[84:87], v1, s[12:15], s40 offen
  s_add_u32 s40, s40, 131072
  buffer_load_dwordx4 v[72:75], v1, s[12:15], s40 offen
  s_add_u32 s40, s40, 131072
  buffer_load_dwordx4 v[76:79], v1, s[12:15], s40 offen
  s_add_u32 s40, s40, 131072
  buffer_load_dwordx4 v[80:83], v1, s[12:15], s40 offen
  s_add_u32 s40, s40, 131072
  buffer_load_dwordx4 v[84:87], v1, s[12:15], s40 offen
  s_add_u32 s40, s40, 131072
  buffer_load_dwordx4 v[72:75], v1, s[12:15], s40 offen
  s_add_u32 s40, s40, 131072
  buffer_load_dwordx4 v[76:79], v1, s[12:15], s40 offen
  s_add_u32 s40, s40, 131072
  buffer_load_dwordx4 v[80:83], v1, s[12:15], s40 offen
  s_add_u32 s40, s40, 131072
  buffer_load_dwordx4 v[84:87], v1, s[12:15], s40 offen
  s_add_u32 s40, s40, 131072
  buffer_load_dwordx4 v[72:75], v1, s[12:15], s40 offen
  s_add_u32 s40, s40, 131072
  buffer_load_dwordx4 v[76:79], v1, s[12:15], s40 offen
  s_add_u32 s40, s40, 131072
  buffer_load_dwordx4 v[80:83], v1, s[12:15], s40 offen
  s_add_u32 s40, s40, 131072
  buffer_load_dwordx4 v[84:87], v1, s[12:15], s40 offen
  s_add_u32 s40, s40, 131072
  s_waitcnt vmcnt(40)
  ds_write_b128 v65, a[0:3] offset:0
  ds_write_b128 v65, a[4:7] offset:1024
  ds_write_b128 v65, a[8:11] offset:2048
  ds_write_b128 v65, a[12:15] offset:3072
  ds_write_b128 v65, a[16:19] offset:4096
  ds_write_b128 v65, a[20:23] offset:5120
  ds_write_b128 v65, a[24:27] offset:6144
  ds_write_b128 v65, a[28:31] offset:7168
  s_waitcnt lgkmcnt(0)
  ds_read_b64_tr_b16 a[0:1], v66 offset:0
  ds_read_b64_tr_b16 a[2:3], v66 offset:256
  ds_read_b64_tr_b16 a[4:5], v66 offset:1024
  ds_read_b64_tr_b16 a[6:7], v66 offset:1280
  ds_read_b64_tr_b16 a[8:9], v66 offset:2048
  ds_read_b64_tr_b16 a[10:11], v66 offset:2304
  ds_read_b64_tr_b16 a[12:13], v66 offset:3072
  ds_read_b64_tr_b16 a[14:15], v66 offset:3328
  ds_read_b64_tr_b16 a[16:17], v66 offset:4096
  ds_read_b64_tr_b16 a[18:19], v66 offset:4352
  ds_read_b64_tr_b16 a[20:21], v66 offset:5120
  ds_read_b64_tr_b16 a[22:23], v66 offset:5376
  ds_read_b64_tr_b16 a[24:25], v66 offset:6144
  ds_read_b64_tr_b16 a[26:27], v66 offset:6400
  ds_read_b64_tr_b16 a[28:29], v66 offset:7168
  ds_read_b64_tr_b16 a[30:31], v66 offset:7424
  s_waitcnt lgkmcnt(0)
  s_waitcnt vmcnt(32)
  ds_write_b128 v65, a[32:35] offset:0
  ds_write_b128 v65, a[36:39] offset:1024
  ds_write_b128 v65, a[40:43] offset:2048
  ds_write_b128 v65, a[44:47] offset:3072
  ds_write_b128 v65, a[48:51] offset:4096
  ds_write_b128 v65, a[52:55] offset:5120
  ds_write_b128 v65, a[56:59] offset:6144
  ds_write_b128 v65, a[60:63] offset:7168
  s_waitcnt lgkmcnt(0)
  ds_read_b64_tr_b16 a[32:33], v66 offset:0
  ds_read_b64_tr_b16 a[34:35], v66 offset:256
  ds_read_b64_tr_b16 a[36:37], v66 offset:1024
  ds_read_b64_tr_b16 a[38:39], v66 offset:1280
  ds_read_b64_tr_b16 a[40:41], v66 offset:2048
  ds_read_b64_tr_b16 a[42:43], v66 offset:2304
  ds_read_b64_tr_b16 a[44:45], v66 offset:3072
  ds_read_b64_tr_b16 a[46:47], v66 offset:3328
  ds_read_b64_tr_b16 a[48:49], v66 offset:4096
  ds_read_b64_tr_b16 a[50:51], v66 offset:4352
  ds_read_b64_tr_b16 a[52:53], v66 offset:5120
  ds_read_b64_tr_b16 a[54:55], v66 offset:5376
  ds_read_b64_tr_b16 a[56:57], v66 offset:6144
  ds_read_b64_tr_b16 a[58:59], v66 offset:6400
  ds_read_b64_tr_b16 a[60:61], v66 offset:7168
  ds_read_b64_tr_b16 a[62:63], v66 offset:7424
  s_waitcnt lgkmcnt(0)
  s_waitcnt vmcnt(24)
  ds_write_b128 v65, a[64:67] offset:0
  ds_write_b128 v65, a[68:71] offset:1024
  ds_write_b128 v65, a[72:75] offset:2048
  ds_write_b128 v65, a[76:79] offset:3072
  ds_write_b128 v65, a[80:83] offset:4096
  ds_write_b128 v65, a[84:87] offset:5120
  ds_write_b128 v65, a[88:91] offset:6144
  ds_write_b128 v65, a[92:95] offset:7168
  s_waitcnt lgkmcnt(0)
  ds_read_b64_tr_b16 a[64:65], v66 offset:0
  ds_read_b64_tr_b16 a[66:67], v66 offset:256
  ds_read_b64_tr_b16 a[68:69], v66 offset:1024
  ds_read_b64_tr_b16 a[70:71], v66 offset:1280
  ds_read_b64_tr_b16 a[72:73], v66 offset:2048
  ds_read_b64_tr_b16 a[74:75], v66 offset:2304
  ds_read_b64_tr_b16 a[76:77], v66 offset:3072
  ds_read_b64_tr_b16 a[78:79], v66 offset:3328
  ds_read_b64_tr_b16 a[80:81], v66 offset:4096
  ds_read_b64_tr_b16 a[82:83], v66 offset:4352
  ds_read_b64_tr_b16 a[84:85], v66 offset:5120
  ds_read_b64_tr_b16 a[86:87], v66 offset:5376
  ds_read_b64_tr_b16 a[88:89], v66 offset:6144
  ds_read_b64_tr_b16 a[90:91], v66 offset:6400
  ds_read_b64_tr_b16 a[92:93], v66 offset:7168
  ds_read_b64_tr_b16 a[94:95], v66 offset:7424
  s_waitcnt lgkmcnt(0)
  s_waitcnt vmcnt(16)
  ds_write_b128 v65, a[96:99] offset:0
  ds_write_b128 v65, a[100:103] offset:1024
  ds_write_b128 v65, a[104:107] offset:2048
  ds_write_b128 v65, a[108:111] offset:3072
  ds_write_b128 v65, a[112:115] offset:4096
  ds_write_b128 v65, a[116:119] offset:5120
  ds_write_b128 v65, a[120:123] offset:6144
  ds_write_b128 v65, a[124:127] offset:7168
  s_waitcnt lgkmcnt(0)
  ds_read_b64_tr_b16 a[96:97], v66 offset:0
  ds_read_b64_tr_b16 a[98:99], v66 offset:256
  ds_read_b64_tr_b16 a[100:101], v66 offset:1024
  ds_read_b64_tr_b16 a[102:103], v66 offset:1280
  ds_read_b64_tr_b16 a[104:105], v66 offset:2048
  ds_read_b64_tr_b16 a[106:107], v66 offset:2304
  ds_read_b64_tr_b16 a[108:109], v66 offset:3072
  ds_read_b64_tr_b16 a[110:111], v66 offset:3328
  ds_read_b64_tr_b16 a[112:113], v66 offset:4096
  ds_read_b64_tr_b16 a[114:115], v66 offset:4352
  ds_read_b64_tr_b16 a[116:117], v66 offset:5120
  ds_read_b64_tr_b16 a[118:119], v66 offset:5376
  ds_read_b64_tr_b16 a[120:121], v66 offset:6144
  ds_read_b64_tr_b16 a[122:123], v66 offset:6400
  ds_read_b64_tr_b16 a[124:125], v66 offset:7168
  ds_read_b64_tr_b16 a[126:127], v66 offset:7424
  s_waitcnt lgkmcnt(0)
  s_cmp_eq_u32 s63, 0
  s_cbranch_scc0 H3_SKIP
  s_cmp_eq_u32 s21, 0
  s_cbranch_scc0 H3_NOSIG
  s_mov_b64 exec, 1
  v_mov_b32 v23, 1
  v_mov_b32 v22, 36
  buffer_atomic_add v23, v22, s[56:59], 0 offen
  s_mov_b64 exec, -1
H3_NOSIG:
H3_SKIP:
  s_mov_b32 s29, 0
  s_lshl_b32 s31, s24, 15
  s_mov_b32 s30, 0
  s_lshl_b32 s40, s21, 13
  s_add_u32 s41, s40, s31
  s_add_u32 s40, s40, s30
  s_mov_b32 m0, s40
  s_add_u32 s40, s40, 1024
  buffer_load_dwordx4 v10, s[12:15], s41 offen lds
  s_add_u32 s41, s41, 1024
  s_mov_b32 m0, s40
  s_add_u32 s40, s40, 1024
  buffer_load_dwordx4 v11, s[12:15], s41 offen lds
  s_add_u32 s41, s41, 1024
  s_mov_b32 m0, s40
  s_add_u32 s40, s40, 1024
  buffer_load_dwordx4 v12, s[12:15], s41 offen lds
  s_add_u32 s41, s41, 1024
  s_mov_b32 m0, s40
  s_add_u32 s40, s40, 1024
  buffer_load_dwordx4 v13, s[12:15], s41 offen lds
  s_add_u32 s41, s41, 1024
  s_mov_b32 m0, s40
  s_add_u32 s40, s40, 1024
  buffer_load_dwordx4 v14, s[12:15], s41 offen lds
  s_add_u32 s41, s41, 1024
  s_mov_b32 m0, s40
  s_add_u32 s40, s40, 1024
  buffer_load_dwordx4 v15, s[12:15], s41 offen lds
  s_add_u32 s41, s41, 1024
  s_mov_b32 m0, s40
  s_add_u32 s40, s40, 1024
  buffer_load_dwordx4 v16, s[12:15], s41 offen lds
  s_add_u32 s41, s41, 1024
  s_mov_b32 m0, s40
  s_nop 0
  buffer_load_dwordx4 v17, s[12:15], s41 offen lds
  s_lshl_b32 s42, s25, 15
  s_add_u32 s31, s31, s42
  s_mov_b32 s30, 32768
  s_lshl_b32 s40, s21, 13
  s_add_u32 s41, s40, s31
  s_add_u32 s40, s40, s30
  s_mov_b32 m0, s40
  s_add_u32 s40, s40, 1024
  buffer_load_dwordx4 v10, s[12:15], s41 offen lds
  s_add_u32 s41, s41, 1024
  s_mov_b32 m0, s40
  s_add_u32 s40, s40, 1024
  buffer_load_dwordx4 v11, s[12:15], s41 offen lds
  s_add_u32 s41, s41, 1024
  s_mov_b32 m0, s40
  s_add_u32 s40, s40, 1024
  buffer_load_dwordx4 v12, s[12:15], s41 offen lds
  s_add_u32 s41, s41, 1024
  s_mov_b32 m0, s40
  s_add_u32 s40, s40, 1024
  buffer_load_dwordx4 v13, s[12:15], s41 offen lds
  s_add_u32 s41, s41, 1024
  s_mov_b32 m0, s40
  s_add_u32 s40, s40, 1024
  buffer_load_dwordx4 v14, s[12:15], s41 offen lds
  s_add_u32 s41, s41, 1024
  s_mov_b32 m0, s40
  s_add_u32 s40, s40, 1024
  buffer_load_dwordx4 v15, s[12:15], s41 offen lds
  s_add_u32 s41, s41, 1024
  s_mov_b32 m0, s40
  s_add_u32 s40, s40, 1024
  buffer_load_dwordx4 v16, s[12:15], s41 offen lds
  s_add_u32 s41, s41, 1024
  s_mov_b32 m0, s40
  s_nop 0
  buffer_load_dwordx4 v17, s[12:15], s41 offen lds
  v_mov_b32 v21, 0x40000000
  buffer_store_dword v21, v21, s[8:11], 0 offen
  buffer_store_dword v21, v21, s[8:11], 0 offen
  s_mov_b32 s22, 0
  s_waitcnt vmcnt(10)
  s_branch GQB_ENTER
GQB_LOOP:
  s_waitcnt vmcnt(13)
GQB_ENTER:
  s_barrier
  s_max_u32 s40, s22, 2
  s_sub_u32 s40, s40, 2
  v_mov_b32 v20, s40
  s_mov_b64 exec, 1
  buffer_store_dword v20, v19, s[8:11], s28 offen sc1
  s_mov_b64 exec, -1
  s_lshl_b32 s42, s25, 15
  s_add_u32 s31, s31, s42
  s_add_u32 s30, s30, 32768
  s_cmp_ge_u32 s30, 98304
  s_cselect_b32 s42, 98304, 0
  s_sub_u32 s30, s30, s42
  s_lshl_b32 s44, s21, 13
  s_add_u32 s45, s44, s31
  s_add_u32 s44, s44, s30
  ds_read_b128 v[40:43], v2 offset:0
  ds_read_b128 v[44:47], v3 offset:0
  ds_read_b128 v[48:51], v4 offset:0
  ds_read_b128 v[52:55], v5 offset:0
  s_waitcnt lgkmcnt(3)
  v_mfma_f32_32x32x16_bf16 v[24:39], a[0:3], v[40:43], 0
  ds_read_b128 v[40:43], v6 offset:0
  s_waitcnt lgkmcnt(3)
  v_mfma_f32_32x32x16_bf16 v[24:39], a[4:7], v[44:47], v[24:39]
  ds_read_b128 v[44:47], v7 offset:0
  s_mov_b32 m0, s44
  s_add_u32 s44, s44, 1024
  s_waitcnt lgkmcnt(3)
  v_mfma_f32_32x32x16_bf16 v[24:39], a[8:11], v[48:51], v[24:39]
  ds_read_b128 v[48:51], v8 offset:0
  buffer_load_dwordx4 v10, s[12:15], s45 offen lds
  s_add_u32 s45, s45, 1024
  s_waitcnt lgkmcnt(3)
  v_mfma_f32_32x32x16_bf16 v[24:39], a[12:15], v[52:55], v[24:39]
  ds_read_b128 v[52:55], v9 offset:0
  s_waitcnt lgkmcnt(3)
  v_mfma_f32_32x32x16_bf16 v[24:39], a[16:19], v[40:43], v[24:39]
  ds_read_b128 v[40:43], v2 offset:256
  s_waitcnt lgkmcnt(3)
  v_mfma_f32_32x32x16_bf16 v[24:39], a[20:23], v[44:47], v[24:39]
  ds_read_b128 v[44:47], v3 offset:256
  s_mov_b32 m0, s44
  s_add_u32 s44, s44, 1024
  s_waitcnt lgkmcnt(3)
  v_mfma_f32_32x32x16_bf16 v[24:39], a[24:27], v[48:51], v[24:39]
  ds_read_b128 v[48:51], v4 offset:256
  buffer_load_dwordx4 v11, s[12:15], s45 offen lds
  s_add_u32 s45, s45, 1024
  s_waitcnt lgkmcnt(3)
  v_mfma_f32_32x32x16_bf16 v[24:39], a[28:31], v[52:55], v[24:39]
  ds_read_b128 v[52:55], v5 offset:256
  s_waitcnt lgkmcnt(3)
  v_mfma_f32_32x32x16_bf16 v[24:39], a[32:35], v[40:43], v[24:39]
  ds_read_b128 v[40:43], v6 offset:256
  s_waitcnt lgkmcnt(3)
  v_mfma_f32_32x32x16_bf16 v[24:39], a[36:39], v[44:47], v[24:39]
  ds_read_b128 v[44:47], v7 offset:256
  s_mov_b32 m0, s44
  s_add_u32 s44, s44, 1024
  s_waitcnt lgkmcnt(3)
  v_mfma_f32_32x32x16_bf16 v[24:39], a[40:43], v[48:51], v[24:39]
  ds_read_b128 v[48:51], v8 offset:256
  buffer_load_dwordx4 v12, s[12:15], s45 offen lds
  s_add_u32 s45, s45, 1024
  s_waitcnt lgkmcnt(3)
  v_mfma_f32_32x32x16_bf16 v[24:39], a[44:47], v[52:55], v[24:39]
  ds_read_b128 v[52:55], v9 offset:256
  s_waitcnt lgkmcnt(3)
  v_mfma_f32_32x32x16_bf16 v[24:39], a[48:51], v[40:43], v[24:39]
  ds_read_b128 v[40:43], v2 offset:512
  s_waitcnt lgkmcnt(3)
  v_mfma_f32_32x32x16_bf16 v[24:39], a[52:55], v[44:47], v[24:39]
  ds_read_b128 v[44:47], v3 offset:512
  s_mov_b32 m0, s44
  s_add_u32 s44, s44, 1024
  s_waitcnt lgkmcnt(3)
  v_mfma_f32_32x32x16_bf16 v[24:39], a[56:59], v[48:51], v[24:39]
  ds_read_b128 v[48:51], v4 offset:512
  buffer_load_dwordx4 v13, s[12:15], s45 offen lds
  s_add_u32 s45, s45, 1024
  s_waitcnt lgkmcnt(3)
  v_mfma_f32_32x32x16_bf16 v[24:39], a[60:63], v[52:55], v[24:39]
  ds_read_b128 v[52:55], v5 offset:512
  s_waitcnt lgkmcnt(3)
  v_mfma_f32_32x32x16_bf16 v[24:39], a[64:67], v[40:43], v[24:39]
  ds_read_b128 v[40:43], v6 offset:512
  s_waitcnt lgkmcnt(3)
  v_mfma_f32_32x32x16_bf16 v[24:39], a[68:71], v[44:47], v[24:39]
  ds_read_b128 v[44:47], v7 offset:512
  s_mov_b32 m0, s44
  s_add_u32 s44, s44, 1024
  s_waitcnt lgkmcnt(3)
  v_mfma_f32_32x32x16_bf16 v[24:39], a[72:75], v[48:51], v[24:39]
  ds_read_b128 v[48:51], v8 offset:512
  buffer_load_dwordx4 v14, s[12:15], s45 offen lds
  s_add_u32 s45, s45, 1024
  s_waitcnt lgkmcnt(3)
  v_mfma_f32_32x32x16_bf16 v[24:39], a[76:79], v[52:55], v[24:39]
  ds_read_b128 v[52:55], v9 offset:512
  s_waitcnt lgkmcnt(3)
  v_mfma_f32_32x32x16_bf16 v[24:39], a[80:83], v[40:43], v[24:39]
  ds_read_b128 v[40:43], v2 offset:768
  s_waitcnt lgkmcnt(3)
  v_mfma_f32_32x32x16_bf16 v[24:39], a[84:87], v[44:47], v[24:39]
  ds_read_b128 v[44:47], v3 offset:768
  s_mov_b32 m0, s44
  s_add_u32 s44, s44, 1024
  s_waitcnt lgkmcnt(3)
  v_mfma_f32_32x32x16_bf16 v[24:39], a[88:91], v[48:51], v[24:39]
  ds_read_b128 v[48:51], v4 offset:768
  buffer_load_dwordx4 v15, s[12:15], s45 offen lds
  s_add_u32 s45, s45, 1024
  s_waitcnt lgkmcnt(3)
  v_mfma_f32_32x32x16_bf16 v[24:39], a[92:95], v[52:55], v[24:39]
  ds_read_b128 v[52:55], v5 offset:768
  s_waitcnt lgkmcnt(3)
  v_mfma_f32_32x32x16_bf16 v[24:39], a[96:99], v[40:43], v[24:39]
  ds_read_b128 v[40:43], v6 offset:768
  s_waitcnt lgkmcnt(3)
  v_mfma_f32_32x32x16_bf16 v[24:39], a[100:103], v[44:47], v[24:39]
  ds_read_b128 v[44:47], v7 offset:768
  s_mov_b32 m0, s44
  s_add_u32 s44, s44, 1024
  s_waitcnt lgkmcnt(3)
  v_mfma_f32_32x32x16_bf16 v[24:39], a[104:107], v[48:51], v[24:39]
  ds_read_b128 v[48:51], v8 offset:768
  buffer_load_dwordx4 v16, s[12:15], s45 offen lds
  s_add_u32 s45, s45, 1024
  s_waitcnt lgkmcnt(3)
  v_mfma_f32_32x32x16_bf16 v[24:39], a[108:111], v[52:55], v[24:39]
  ds_read_b128 v[52:55], v9 offset:768
  s_waitcnt lgkmcnt(3)
  v_mfma_f32_32x32x16_bf16 v[24:39], a[112:115], v[40:43], v[24:39]
  s_waitcnt lgkmcnt(2)
  v_mfma_f32_32x32x16_bf16 v[24:39], a[116:119], v[44:47], v[24:39]
  s_mov_b32 m0, s44
  s_add_u32 s44, s44, 1024
  s_waitcnt lgkmcnt(1)
  v_mfma_f32_32x32x16_bf16 v[24:39], a[120:123], v[48:51], v[24:39]
  buffer_load_dwordx4 v17, s[12:15], s45 offen lds
  s_add_u32 s45, s45, 1024
  s_waitcnt lgkmcnt(0)
  v_mfma_f32_32x32x16_bf16 v[24:39], a[124:127], v[52:55], v[24:39]
  s_add_u32 s29, s29, 32768
  s_cmp_ge_u32 s29, 98304
  s_mov_b32 s40, 32768
  s_cselect_b32 s40, 4294901760, s40
  s_cselect_b32 s41, 0, s29
  s_mov_b32 s29, s41
  v_add_u32 v2, s40, v2
  v_add_u32 v3, s40, v3
  v_add_u32 v4, s40, v4
  v_add_u32 v5, s40, v5
  v_add_u32 v6, s40, v6
  v_add_u32 v7, s40, v7
  v_add_u32 v8, s40, v8
  v_add_u32 v9, s40, v9
  s_nop 3
  s_mov_b32 s40, 0x3eb8aa3b
  v_mul_f32 v24, s40, v24
  v_mul_f32 v25, s40, v25
  v_mul_f32 v26, s40, v26
  v_mul_f32 v27, s40, v27
  v_mul_f32 v28, s40, v28
  v_mul_f32 v29, s40, v29
  v_mul_f32 v30, s40, v30
  v_mul_f32 v31, s40, v31
  v_mul_f32 v32, s40, v32
  v_mul_f32 v33, s40, v33
  v_mul_f32 v34, s40, v34
  v_mul_f32 v35, s40, v35
  v_mul_f32 v36, s40, v36
  v_mul_f32 v37, s40, v37
  v_mul_f32 v38, s40, v38
  v_mul_f32 v39, s40, v39
  v_cvt_pk_bf16_f32 v56, v24, v25
  v_cvt_pk_bf16_f32 v57, v26, v27
  v_cvt_pk_bf16_f32 v58, v28, v29
  v_cvt_pk_bf16_f32 v59, v30, v31
  v_cvt_pk_bf16_f32 v60, v32, v33
  v_cvt_pk_bf16_f32 v61, v34, v35
  v_cvt_pk_bf16_f32 v62, v36, v37
  v_cvt_pk_bf16_f32 v63, v38, v39
  s_mul_i32 s40, s24, s27
  s_add_u32 s40, s40, s26
  buffer_store_dwordx4 v[56:59], v1, s[8:11], s40 offen sc1
  buffer_store_dwordx4 v[60:63], v1, s[8:11], s40 offen offset:1024 sc1
  s_add_u32 s24, s24, s25
  s_add_u32 s22, s22, 1
  s_cmp_lt_u32 s22, s23
  s_cbranch_scc1 GQB_LOOP
  s_waitcnt vmcnt(0)
  s_barrier
  s_cmp_eq_u32 s21, 0
  s_cbranch_scc0 GQB_END
  v_mov_b32 v20, s23
  s_mov_b64 exec, 1
  buffer_store_dword v20, v19, s[8:11], s28 offen sc1
  s_mov_b64 exec, -1
  s_waitcnt vmcnt(0)
GQB_END:
  s_branch G_DONE
G_SMROLE:
  s_cmp_lt_u32 s94, 216
  s_cbranch_scc0 G_IDLE
  s_sub_u32 s44, s94, 208
  s_lshl_b32 s24, s44, 3
  s_mov_b32 s25, 1
  s_mov_b32 s23, 8
  s_mov_b32 s32, 32
  s_mov_b32 s33, 0
  s_cmp_eq_u32 s21, 1
  s_cselect_b32 s40, s80, s78
  s_cselect_b32 s41, s81, s79
  s_mov_b32 s16, s40
  s_and_b32 s17, s41, 0xffff
  s_mov_b32 s18, 0x4000
  s_mov_b32 s19, 0x20000
  s_mov_b32 s48, s84
  s_and_b32 s49, s85, 0xffff
  s_mov_b32 s50, 0x400
  s_mov_b32 s51, 0x20000
  v_bfe_u32 v20, v0, 5, 1
  v_lshlrev_b32 v18, 8, v20
  v_bfe_u32 v20, v0, 0, 4
  v_lshl_add_u32 v18, v20, 4, v18
  v_bfe_u32 v20, v0, 2, 4
  v_lshlrev_b32 v64, 5, v20
  v_bfe_u32 v20, v0, 0, 1
  v_lshl_add_u32 v64, v20, 4, v64
  v_bfe_u32 v20, v0, 1, 1
  v_lshl_add_u32 v64, v20, 24, v64
  s_lshl_b32 s40, s21, 13
  s_add_u32 s40, s40, 98304
  v_bfe_u32 v20, v0, 4, 2
  v_lshlrev_b32 v65, 8, v20
  v_bfe_u32 v20, v0, 1, 1
  v_lshl_add_u32 v65, v20, 7, v65
  v_bfe_u32 v20, v0, 2, 2
  v_lshl_add_u32 v65, v20, 5, v65
  v_bfe_u32 v20, v0, 0, 1
  v_lshl_add_u32 v65, v20, 4, v65
  v_add_u32 v65, s40, v65
  v_bfe_u32 v20, v0, 5, 1
  v_lshlrev_b32 v66, 9, v20
  v_bfe_u32 v20, v0, 4, 1
  v_lshl_add_u32 v66, v20, 7, v66
  v_bfe_u32 v20, v0, 2, 2
  v_lshl_add_u32 v66, v20, 5, v66
  v_bfe_u32 v20, v0, 0, 2
  v_lshl_add_u32 v66, v20, 3, v66
  v_add_u32 v66, s40, v66
  s_lshl_b32 s41, s32, 4
  s_mov_b32 s40, s33
  buffer_load_dwordx4 a[0:3], v64, s[16:19], s40 offen
  s_add_u32 s40, s40, s41
  buffer_load_dwordx4 a[4:7], v64, s[16:19], s40 offen
  s_add_u32 s40, s40, s41
  buffer_load_dwordx4 a[8:11], v64, s[16:19], s40 offen
  s_add_u32 s40, s40, s41
  buffer_load_dwordx4 a[12:15], v64, s[16:19], s40 offen
  s_add_u32 s40, s40, s41
  buffer_load_dwordx4 a[16:19], v64, s[16:19], s40 offen
  s_add_u32 s40, s40, s41
  buffer_load_dwordx4 a[20:23], v64, s[16:19], s40 offen
  s_add_u32 s40, s40, s41
  buffer_load_dwordx4 a[24:27], v64, s[16:19], s40 offen
  s_add_u32 s40, s40, s41
  buffer_load_dwordx4 a[28:31], v64, s[16:19], s40 offen
  s_add_u32 s40, s40, s41
  buffer_load_dwordx4 a[32:35], v64, s[16:19], s40 offen
  s_add_u32 s40, s40, s41
  buffer_load_dwordx4 a[36:39], v64, s[16:19], s40 offen
  s_add_u32 s40, s40, s41
  buffer_load_dwordx4 a[40:43], v64, s[16:19], s40 offen
  s_add_u32 s40, s40, s41
  buffer_load_dwordx4 a[44:47], v64, s[16:19], s40 offen
  s_add_u32 s40, s40, s41
  buffer_load_dwordx4 a[48:51], v64, s[16:19], s40 offen
  s_add_u32 s40, s40, s41
  buffer_load_dwordx4 a[52:55], v64, s[16:19], s40 offen
  s_add_u32 s40, s40, s41
  buffer_load_dwordx4 a[56:59], v64, s[16:19], s40 offen
  s_add_u32 s40, s40, s41
  buffer_load_dwordx4 a[60:63], v64, s[16:19], s40 offen
  s_add_u32 s40, s40, s41
  buffer_load_dwordx4 a[64:67], v64, s[16:19], s40 offen
  s_add_u32 s40, s40, s41
  buffer_load_dwordx4 a[68:71], v64, s[16:19], s40 offen
  s_add_u32 s40, s40, s41
  buffer_load_dwordx4 a[72:75], v64, s[16:19], s40 offen
  s_add_u32 s40, s40, s41
  buffer_load_dwordx4 a[76:79], v64, s[16:19], s40 offen
  s_add_u32 s40, s40, s41
  buffer_load_dwordx4 a[80:83], v64, s[16:19], s40 offen
  s_add_u32 s40, s40, s41
  buffer_load_dwordx4 a[84:87], v64, s[16:19], s40 offen
  s_add_u32 s40, s40, s41
  buffer_load_dwordx4 a[88:91], v64, s[16:19], s40 offen
  s_add_u32 s40, s40, s41
  buffer_load_dwordx4 a[92:95], v64, s[16:19], s40 offen
  s_add_u32 s40, s40, s41
  buffer_load_dwordx4 a[96:99], v64, s[16:19], s40 offen
  s_add_u32 s40, s40, s41
  buffer_load_dwordx4 a[100:103], v64, s[16:19], s40 offen
  s_add_u32 s40, s40, s41
  buffer_load_dwordx4 a[104:107], v64, s[16:19], s40 offen
  s_add_u32 s40, s40, s41
  buffer_load_dwordx4 a[108:111], v64, s[16:19], s40 offen
  s_add_u32 s40, s40, s41
  buffer_load_dwordx4 a[112:115], v64, s[16:19], s40 offen
  s_add_u32 s40, s40, s41
  buffer_load_dwordx4 a[116:119], v64, s[16:19], s40 offen
  s_add_u32 s40, s40, s41
  buffer_load_dwordx4 a[120:123], v64, s[16:19], s40 offen
  s_add_u32 s40, s40, s41
  buffer_load_dwordx4 a[124:127], v64, s[16:19], s40 offen
  s_add_u32 s40, s40, s41
  s_lshl_b32 s40, s20, 10
  s_lshl_b32 s41, s21, 19
  s_lshl_b32 s41, s21, 15
  s_add_u32 s40, s40, s41
  buffer_load_dwordx4 v[72:75], v1, s[12:15], s40 offen
  s_add_u32 s40, s40, 131072
  buffer_load_dwordx4 v[76:79], v1, s[12:15], s40 offen
  s_add_u32 s40, s40, 131072
  buffer_load_dwordx4 v[80:83], v1, s[12:15], s40 offen
  s_add_u32 s40, s40, 131072
  buffer_load_dwordx4 v[84:87], v1, s[12:15], s40 offen
  s_add_u32 s40, s40, 131072
  buffer_load_dwordx4 v[72:75], v1, s[12:15], s40 offen
  s_add_u32 s40, s40, 131072
  buffer_load_dwordx4 v[76:79], v1, s[12:15], s40 offen
  s_add_u32 s40, s40, 131072
  buffer_load_dwordx4 v[80:83], v1, s[12:15], s40 offen
  s_add_u32 s40, s40, 131072
  buffer_load_dwordx4 v[84:87], v1, s[12:15], s40 offen
  s_add_u32 s40, s40, 131072
  buffer_load_dwordx4 v[72:75], v1, s[12:15], s40 offen
  s_add_u32 s40, s40, 131072
  buffer_load_dwordx4 v[76:79], v1, s[12:15], s40 offen
  s_add_u32 s40, s40, 131072
  buffer_load_dwordx4 v[80:83], v1, s[12:15], s40 offen
  s_add_u32 s40, s40, 131072
  buffer_load_dwordx4 v[84:87], v1, s[12:15], s40 offen
  s_add_u32 s40, s40, 131072
  buffer_load_dwordx4 v[72:75], v1, s[12:15], s40 offen
  s_add_u32 s40, s40, 131072
  buffer_load_dwordx4 v[76:79], v1, s[12:15], s40 offen
  s_add_u32 s40, s40, 131072
  buffer_load_dwordx4 v[80:83], v1, s[12:15], s40 offen
  s_add_u32 s40, s40, 131072
  buffer_load_dwordx4 v[84:87], v1, s[12:15], s40 offen
  s_add_u32 s40, s40, 131072
  v_bfe_u32 v20, v0, 2, 4
  v_lshlrev_b32 v67, 1, v20
  v_and_b32 v20, 3, v0
  v_cmp_ne_u32 vcc, 2, v20
  v_mov_b32 v21, 0x1000000
  s_nop 0
  v_cndmask_b32 v67, v67, v21, vcc
  s_cmp_eq_u32 s21, 0
  s_cbranch_scc0 GSM_NOGATE
  buffer_load_ushort v72, v67, s[48:51], 0 offen offset:0
  buffer_load_ushort v73, v67, s[48:51], 0 offen offset:32
  buffer_load_ushort v74, v67, s[48:51], 0 offen offset:64
  buffer_load_ushort v75, v67, s[48:51], 0 offen offset:96
  buffer_load_ushort v76, v67, s[48:51], 0 offen offset:128
  buffer_load_ushort v77, v67, s[48:51], 0 offen offset:160
  buffer_load_ushort v78, v67, s[48:51], 0 offen offset:192
  buffer_load_ushort v79, v67, s[48:51], 0 offen offset:224
  buffer_load_ushort v80, v67, s[48:51], 0 offen offset:256
  buffer_load_ushort v81, v67, s[48:51], 0 offen offset:288
  buffer_load_ushort v82, v67, s[48:51], 0 offen offset:320
  buffer_load_ushort v83, v67, s[48:51], 0 offen offset:352
  buffer_load_ushort v84, v67, s[48:51], 0 offen offset:384
  buffer_load_ushort v85, v67, s[48:51], 0 offen offset:416
  buffer_load_ushort v86, v67, s[48:51], 0 offen offset:448
  buffer_load_ushort v87, v67, s[48:51], 0 offen offset:480
  buffer_load_ushort v88, v67, s[48:51], 0 offen offset:512
  buffer_load_ushort v89, v67, s[48:51], 0 offen offset:544
  buffer_load_ushort v90, v67, s[48:51], 0 offen offset:576
  buffer_load_ushort v91, v67, s[48:51], 0 offen offset:608
  buffer_load_ushort v92, v67, s[48:51], 0 offen offset:640
  buffer_load_ushort v93, v67, s[48:51], 0 offen offset:672
  buffer_load_ushort v94, v67, s[48:51], 0 offen offset:704
  buffer_load_ushort v95, v67, s[48:51], 0 offen offset:736
  buffer_load_ushort v96, v67, s[48:51], 0 offen offset:768
  buffer_load_ushort v97, v67, s[48:51], 0 offen offset:800
  buffer_load_ushort v98, v67, s[48:51], 0 offen offset:832
  buffer_load_ushort v99, v67, s[48:51], 0 offen offset:864
  buffer_load_ushort v100, v67, s[48:51], 0 offen offset:896
  buffer_load_ushort v101, v67, s[48:51], 0 offen offset:928
  buffer_load_ushort v102, v67, s[48:51], 0 offen offset:960
  buffer_load_ushort v103, v67, s[48:51], 0 offen offset:992
  s_waitcnt vmcnt(0)
  v_accvgpr_read_b32 v20, a0
  v_or_b32 v20, v20, v72
  v_accvgpr_write_b32 a0, v20
  v_accvgpr_read_b32 v20, a4
  v_or_b32 v20, v20, v73
  v_accvgpr_write_b32 a4, v20
  v_accvgpr_read_b32 v20, a8
  v_or_b32 v20, v20, v74
  v_accvgpr_write_b32 a8, v20
  v_accvgpr_read_b32 v20, a12
  v_or_b32 v20, v20, v75
  v_accvgpr_write_b32 a12, v20
  v_accvgpr_read_b32 v20, a16
  v_or_b32 v20, v20, v76
  v_accvgpr_write_b32 a16, v20
  v_accvgpr_read_b32 v20, a20
  v_or_b32 v20, v20, v77
  v_accvgpr_write_b32 a20, v20
  v_accvgpr_read_b32 v20, a24
  v_or_b32 v20, v20, v78
  v_accvgpr_write_b32 a24, v20
  v_accvgpr_read_b32 v20, a28
  v_or_b32 v20, v20, v79
  v_accvgpr_write_b32 a28, v20
  v_accvgpr_read_b32 v20, a32
  v_or_b32 v20, v20, v80
  v_accvgpr_write_b32 a32, v20
  v_accvgpr_read_b32 v20, a36
  v_or_b32 v20, v20, v81
  v_accvgpr_write_b32 a36, v20
  v_accvgpr_read_b32 v20, a40
  v_or_b32 v20, v20, v82
  v_accvgpr_write_b32 a40, v20
  v_accvgpr_read_b32 v20, a44
  v_or_b32 v20, v20, v83
  v_accvgpr_write_b32 a44, v20
  v_accvgpr_read_b32 v20, a48
  v_or_b32 v20, v20, v84
  v_accvgpr_write_b32 a48, v20
  v_accvgpr_read_b32 v20, a52
  v_or_b32 v20, v20, v85
  v_accvgpr_write_b32 a52, v20
  v_accvgpr_read_b32 v20, a56
  v_or_b32 v20, v20, v86
  v_accvgpr_write_b32 a56, v20
  v_accvgpr_read_b32 v20, a60
  v_or_b32 v20, v20, v87
  v_accvgpr_write_b32 a60, v20
  v_accvgpr_read_b32 v20, a64
  v_or_b32 v20, v20, v88
  v_accvgpr_write_b32 a64, v20
  v_accvgpr_read_b32 v20, a68
  v_or_b32 v20, v20, v89
  v_accvgpr_write_b32 a68, v20
  v_accvgpr_read_b32 v20, a72
  v_or_b32 v20, v20, v90
  v_accvgpr_write_b32 a72, v20
  v_accvgpr_read_b32 v20, a76
  v_or_b32 v20, v20, v91
  v_accvgpr_write_b32 a76, v20
  v_accvgpr_read_b32 v20, a80
  v_or_b32 v20, v20, v92
  v_accvgpr_write_b32 a80, v20
  v_accvgpr_read_b32 v20, a84
  v_or_b32 v20, v20, v93
  v_accvgpr_write_b32 a84, v20
  v_accvgpr_read_b32 v20, a88
  v_or_b32 v20, v20, v94
  v_accvgpr_write_b32 a88, v20
  v_accvgpr_read_b32 v20, a92
  v_or_b32 v20, v20, v95
  v_accvgpr_write_b32 a92, v20
  v_accvgpr_read_b32 v20, a96
  v_or_b32 v20, v20, v96
  v_accvgpr_write_b32 a96, v20
  v_accvgpr_read_b32 v20, a100
  v_or_b32 v20, v20, v97
  v_accvgpr_write_b32 a100, v20
  v_accvgpr_read_b32 v20, a104
  v_or_b32 v20, v20, v98
  v_accvgpr_write_b32 a104, v20
  v_accvgpr_read_b32 v20, a108
  v_or_b32 v20, v20, v99
  v_accvgpr_write_b32 a108, v20
  v_accvgpr_read_b32 v20, a112
  v_or_b32 v20, v20, v100
  v_accvgpr_write_b32 a112, v20
  v_accvgpr_read_b32 v20, a116
  v_or_b32 v20, v20, v101
  v_accvgpr_write_b32 a116, v20
  v_accvgpr_read_b32 v20, a120
  v_or_b32 v20, v20, v102
  v_accvgpr_write_b32 a120, v20
  v_accvgpr_read_b32 v20, a124
  v_or_b32 v20, v20, v103
  v_accvgpr_write_b32 a124, v20
  s_nop 1
GSM_NOGATE:
  s_waitcnt vmcnt(0)
  ds_write_b128 v65, a[0:3] offset:0
  ds_write_b128 v65, a[4:7] offset:1024
  ds_write_b128 v65, a[8:11] offset:2048
  ds_write_b128 v65, a[12:15] offset:3072
  ds_write_b128 v65, a[16:19] offset:4096
  ds_write_b128 v65, a[20:23] offset:5120
  ds_write_b128 v65, a[24:27] offset:6144
  ds_write_b128 v65, a[28:31] offset:7168
  s_waitcnt lgkmcnt(0)
  ds_read_b64_tr_b16 a[0:1], v66 offset:0
  ds_read_b64_tr_b16 a[2:3], v66 offset:256
  ds_read_b64_tr_b16 a[4:5], v66 offset:1024
  ds_read_b64_tr_b16 a[6:7], v66 offset:1280
  ds_read_b64_tr_b16 a[8:9], v66 offset:2048
  ds_read_b64_tr_b16 a[10:11], v66 offset:2304
  ds_read_b64_tr_b16 a[12:13], v66 offset:3072
  ds_read_b64_tr_b16 a[14:15], v66 offset:3328
  ds_read_b64_tr_b16 a[16:17], v66 offset:4096
  ds_read_b64_tr_b16 a[18:19], v66 offset:4352
  ds_read_b64_tr_b16 a[20:21], v66 offset:5120
  ds_read_b64_tr_b16 a[22:23], v66 offset:5376
  ds_read_b64_tr_b16 a[24:25], v66 offset:6144
  ds_read_b64_tr_b16 a[26:27], v66 offset:6400
  ds_read_b64_tr_b16 a[28:29], v66 offset:7168
  ds_read_b64_tr_b16 a[30:31], v66 offset:7424
  s_waitcnt lgkmcnt(0)
  ds_write_b128 v65, a[32:35] offset:0
  ds_write_b128 v65, a[36:39] offset:1024
  ds_write_b128 v65, a[40:43] offset:2048
  ds_write_b128 v65, a[44:47] offset:3072
  ds_write_b128 v65, a[48:51] offset:4096
  ds_write_b128 v65, a[52:55] offset:5120
  ds_write_b128 v65, a[56:59] offset:6144
  ds_write_b128 v65, a[60:63] offset:7168
  s_waitcnt lgkmcnt(0)
  ds_read_b64_tr_b16 a[32:33], v66 offset:0
  ds_read_b64_tr_b16 a[34:35], v66 offset:256
  ds_read_b64_tr_b16 a[36:37], v66 offset:1024
  ds_read_b64_tr_b16 a[38:39], v66 offset:1280
  ds_read_b64_tr_b16 a[40:41], v66 offset:2048
  ds_read_b64_tr_b16 a[42:43], v66 offset:2304
  ds_read_b64_tr_b16 a[44:45], v66 offset:3072
  ds_read_b64_tr_b16 a[46:47], v66 offset:3328
  ds_read_b64_tr_b16 a[48:49], v66 offset:4096
  ds_read_b64_tr_b16 a[50:51], v66 offset:4352
  ds_read_b64_tr_b16 a[52:53], v66 offset:5120
  ds_read_b64_tr_b16 a[54:55], v66 offset:5376
  ds_read_b64_tr_b16 a[56:57], v66 offset:6144
  ds_read_b64_tr_b16 a[58:59], v66 offset:6400
  ds_read_b64_tr_b16 a[60:61], v66 offset:7168
  ds_read_b64_tr_b16 a[62:63], v66 offset:7424
  s_waitcnt lgkmcnt(0)
  ds_write_b128 v65, a[64:67] offset:0
  ds_write_b128 v65, a[68:71] offset:1024
  ds_write_b128 v65, a[72:75] offset:2048
  ds_write_b128 v65, a[76:79] offset:3072
  ds_write_b128 v65, a[80:83] offset:4096
  ds_write_b128 v65, a[84:87] offset:5120
  ds_write_b128 v65, a[88:91] offset:6144
  ds_write_b128 v65, a[92:95] offset:7168
  s_waitcnt lgkmcnt(0)
  ds_read_b64_tr_b16 a[64:65], v66 offset:0
  ds_read_b64_tr_b16 a[66:67], v66 offset:256
  ds_read_b64_tr_b16 a[68:69], v66 offset:1024
  ds_read_b64_tr_b16 a[70:71], v66 offset:1280
  ds_read_b64_tr_b16 a[72:73], v66 offset:2048
  ds_read_b64_tr_b16 a[74:75], v66 offset:2304
  ds_read_b64_tr_b16 a[76:77], v66 offset:3072
  ds_read_b64_tr_b16 a[78:79], v66 offset:3328
  ds_read_b64_tr_b16 a[80:81], v66 offset:4096
  ds_read_b64_tr_b16 a[82:83], v66 offset:4352
  ds_read_b64_tr_b16 a[84:85], v66 offset:5120
  ds_read_b64_tr_b16 a[86:87], v66 offset:5376
  ds_read_b64_tr_b16 a[88:89], v66 offset:6144
  ds_read_b64_tr_b16 a[90:91], v66 offset:6400
  ds_read_b64_tr_b16 a[92:93], v66 offset:7168
  ds_read_b64_tr_b16 a[94:95], v66 offset:7424
  s_waitcnt lgkmcnt(0)
  ds_write_b128 v65, a[96:99] offset:0
  ds_write_b128 v65, a[100:103] offset:1024
  ds_write_b128 v65, a[104:107] offset:2048
  ds_write_b128 v65, a[108:111] offset:3072
  ds_write_b128 v65, a[112:115] offset:4096
  ds_write_b128 v65, a[116:119] offset:5120
  ds_write_b128 v65, a[120:123] offset:6144
  ds_write_b128 v65, a[124:127] offset:7168
  s_waitcnt lgkmcnt(0)
  ds_read_b64_tr_b16 a[96:97], v66 offset:0
  ds_read_b64_tr_b16 a[98:99], v66 offset:256
  ds_read_b64_tr_b16 a[100:101], v66 offset:1024
  ds_read_b64_tr_b16 a[102:103], v66 offset:1280
  ds_read_b64_tr_b16 a[104:105], v66 offset:2048
  ds_read_b64_tr_b16 a[106:107], v66 offset:2304
  ds_read_b64_tr_b16 a[108:109], v66 offset:3072
  ds_read_b64_tr_b16 a[110:111], v66 offset:3328
  ds_read_b64_tr_b16 a[112:113], v66 offset:4096
  ds_read_b64_tr_b16 a[114:115], v66 offset:4352
  ds_read_b64_tr_b16 a[116:117], v66 offset:5120
  ds_read_b64_tr_b16 a[118:119], v66 offset:5376
  ds_read_b64_tr_b16 a[120:121], v66 offset:6144
  ds_read_b64_tr_b16 a[122:123], v66 offset:6400
  ds_read_b64_tr_b16 a[124:125], v66 offset:7168
  ds_read_b64_tr_b16 a[126:127], v66 offset:7424
  s_waitcnt lgkmcnt(0)
  s_cmp_eq_u32 s63, 0
  s_cbranch_scc0 H4_SKIP
  s_cmp_eq_u32 s21, 0
  s_cbranch_scc0 H4_NOSIG
  s_mov_b64 exec, 1
  v_mov_b32 v23, 1
  v_mov_b32 v22, 36
  buffer_atomic_add v23, v22, s[56:59], 0 offen
  s_mov_b64 exec, -1
H4_NOSIG:
H4_SKIP:
  s_mov_b32 s29, 0
  s_lshl_b32 s31, s24, 15
  s_mov_b32 s30, 0
  s_lshl_b32 s40, s21, 13
  s_add_u32 s41, s40, s31
  s_add_u32 s40, s40, s30
  s_mov_b32 m0, s40
  s_add_u32 s40, s40, 1024
  buffer_load_dwordx4 v10, s[12:15], s41 offen lds
  s_add_u32 s41, s41, 1024
  s_mov_b32 m0, s40
  s_add_u32 s40, s40, 1024
  buffer_load_dwordx4 v11, s[12:15], s41 offen lds
  s_add_u32 s41, s41, 1024
  s_mov_b32 m0, s40
  s_add_u32 s40, s40, 1024
  buffer_load_dwordx4 v12, s[12:15], s41 offen lds
  s_add_u32 s41, s41, 1024
  s_mov_b32 m0, s40
  s_add_u32 s40, s40, 1024
  buffer_load_dwordx4 v13, s[12:15], s41 offen lds
  s_add_u32 s41, s41, 1024
  s_mov_b32 m0, s40
  s_add_u32 s40, s40, 1024
  buffer_load_dwordx4 v14, s[12:15], s41 offen lds
  s_add_u32 s41, s41, 1024
  s_mov_b32 m0, s40
  s_add_u32 s40, s40, 1024
  buffer_load_dwordx4 v15, s[12:15], s41 offen lds
  s_add_u32 s41, s41, 1024
  s_mov_b32 m0, s40
  s_add_u32 s40, s40, 1024
  buffer_load_dwordx4 v16, s[12:15], s41 offen lds
  s_add_u32 s41, s41, 1024
  s_mov_b32 m0, s40
  s_nop 0
  buffer_load_dwordx4 v17, s[12:15], s41 offen lds
  s_lshl_b32 s42, s25, 15
  s_add_u32 s31, s31, s42
  s_mov_b32 s30, 32768
  s_lshl_b32 s40, s21, 13
  s_add_u32 s41, s40, s31
  s_add_u32 s40, s40, s30
  s_mov_b32 m0, s40
  s_add_u32 s40, s40, 1024
  buffer_load_dwordx4 v10, s[12:15], s41 offen lds
  s_add_u32 s41, s41, 1024
  s_mov_b32 m0, s40
  s_add_u32 s40, s40, 1024
  buffer_load_dwordx4 v11, s[12:15], s41 offen lds
  s_add_u32 s41, s41, 1024
  s_mov_b32 m0, s40
  s_add_u32 s40, s40, 1024
  buffer_load_dwordx4 v12, s[12:15], s41 offen lds
  s_add_u32 s41, s41, 1024
  s_mov_b32 m0, s40
  s_add_u32 s40, s40, 1024
  buffer_load_dwordx4 v13, s[12:15], s41 offen lds
  s_add_u32 s41, s41, 1024
  s_mov_b32 m0, s40
  s_add_u32 s40, s40, 1024
  buffer_load_dwordx4 v14, s[12:15], s41 offen lds
  s_add_u32 s41, s41, 1024
  s_mov_b32 m0, s40
  s_add_u32 s40, s40, 1024
  buffer_load_dwordx4 v15, s[12:15], s41 offen lds
  s_add_u32 s41, s41, 1024
  s_mov_b32 m0, s40
  s_add_u32 s40, s40, 1024
  buffer_load_dwordx4 v16, s[12:15], s41 offen lds
  s_add_u32 s41, s41, 1024
  s_mov_b32 m0, s40
  s_nop 0
  buffer_load_dwordx4 v17, s[12:15], s41 offen lds
  v_mov_b32 v21, 0x40000000
  buffer_store_dword v21, v21, s[8:11], 0 offen
  buffer_store_dword v21, v21, s[8:11], 0 offen
  s_mov_b32 s22, 0
  s_waitcnt vmcnt(10)
  s_branch GSM_ENTER
GSM_LOOP:
  s_waitcnt vmcnt(13)
GSM_ENTER:
  s_barrier
  s_max_u32 s40, s22, 2
  s_sub_u32 s40, s40, 2
  v_mov_b32 v20, s40
  s_mov_b64 exec, 1
  buffer_store_dword v20, v19, s[8:11], s28 offen sc1
  s_mov_b64 exec, -1
  s_lshl_b32 s42, s25, 15
  s_add_u32 s31, s31, s42
  s_add_u32 s30, s30, 32768
  s_cmp_ge_u32 s30, 98304
  s_cselect_b32 s42, 98304, 0
  s_sub_u32 s30, s30, s42
  s_lshl_b32 s44, s21, 13
  s_add_u32 s45, s44, s31
  s_add_u32 s44, s44, s30
  ds_read_b128 v[40:43], v2 offset:0
  ds_read_b128 v[44:47], v3 offset:0
  ds_read_b128 v[48:51], v4 offset:0
  ds_read_b128 v[52:55], v5 offset:0
  s_cmp_eq_u32 s21, 1
  s_cbranch_scc1 GSM_SMV
  s_waitcnt lgkmcnt(3)
  v_mfma_f32_32x32x16_bf16 v[24:39], a[0:3], v[40:43], 0
  ds_read_b128 v[40:43], v6 offset:0
  s_waitcnt lgkmcnt(3)
  v_mfma_f32_32x32x16_bf16 v[24:39], a[4:7], v[44:47], v[24:39]
  ds_read_b128 v[44:47], v7 offset:0
  s_mov_b32 m0, s44
  s_add_u32 s44, s44, 1024
  s_waitcnt lgkmcnt(3)
  v_mfma_f32_32x32x16_bf16 v[24:39], a[8:11], v[48:51], v[24:39]
  ds_read_b128 v[48:51], v8 offset:0
  buffer_load_dwordx4 v10, s[12:15], s45 offen lds
  s_add_u32 s45, s45, 1024
  s_waitcnt lgkmcnt(3)
  v_mfma_f32_32x32x16_bf16 v[24:39], a[12:15], v[52:55], v[24:39]
  ds_read_b128 v[52:55], v9 offset:0
  s_waitcnt lgkmcnt(3)
  v_mfma_f32_32x32x16_bf16 v[24:39], a[16:19], v[40:43], v[24:39]
  ds_read_b128 v[40:43], v2 offset:256
  s_waitcnt lgkmcnt(3)
  v_mfma_f32_32x32x16_bf16 v[24:39], a[20:23], v[44:47], v[24:39]
  ds_read_b128 v[44:47], v3 offset:256
  s_mov_b32 m0, s44
  s_add_u32 s44, s44, 1024
  s_waitcnt lgkmcnt(3)
  v_mfma_f32_32x32x16_bf16 v[24:39], a[24:27], v[48:51], v[24:39]
  ds_read_b128 v[48:51], v4 offset:256
  buffer_load_dwordx4 v11, s[12:15], s45 offen lds
  s_add_u32 s45, s45, 1024
  s_waitcnt lgkmcnt(3)
  v_mfma_f32_32x32x16_bf16 v[24:39], a[28:31], v[52:55], v[24:39]
  ds_read_b128 v[52:55], v5 offset:256
  s_waitcnt lgkmcnt(3)
  v_mfma_f32_32x32x16_bf16 v[24:39], a[32:35], v[40:43], v[24:39]
  ds_read_b128 v[40:43], v6 offset:256
  s_waitcnt lgkmcnt(3)
  v_mfma_f32_32x32x16_bf16 v[24:39], a[36:39], v[44:47], v[24:39]
  ds_read_b128 v[44:47], v7 offset:256
  s_mov_b32 m0, s44
  s_add_u32 s44, s44, 1024
  s_waitcnt lgkmcnt(3)
  v_mfma_f32_32x32x16_bf16 v[24:39], a[40:43], v[48:51], v[24:39]
  ds_read_b128 v[48:51], v8 offset:256
  buffer_load_dwordx4 v12, s[12:15], s45 offen lds
  s_add_u32 s45, s45, 1024
  s_waitcnt lgkmcnt(3)
  v_mfma_f32_32x32x16_bf16 v[24:39], a[44:47], v[52:55], v[24:39]
  ds_read_b128 v[52:55], v9 offset:256
  s_waitcnt lgkmcnt(3)
  v_mfma_f32_32x32x16_bf16 v[24:39], a[48:51], v[40:43], v[24:39]
  ds_read_b128 v[40:43], v2 offset:512
  s_waitcnt lgkmcnt(3)
  v_mfma_f32_32x32x16_bf16 v[24:39], a[52:55], v[44:47], v[24:39]
  ds_read_b128 v[44:47], v3 offset:512
  s_mov_b32 m0, s44
  s_add_u32 s44, s44, 1024
  s_waitcnt lgkmcnt(3)
  v_mfma_f32_32x32x16_bf16 v[24:39], a[56:59], v[48:51], v[24:39]
  ds_read_b128 v[48:51], v4 offset:512
  buffer_load_dwordx4 v13, s[12:15], s45 offen lds
  s_add_u32 s45, s45, 1024
  s_waitcnt lgkmcnt(3)
  v_mfma_f32_32x32x16_bf16 v[24:39], a[60:63], v[52:55], v[24:39]
  ds_read_b128 v[52:55], v5 offset:512
  s_waitcnt lgkmcnt(3)
  v_mfma_f32_32x32x16_bf16 v[24:39], a[64:67], v[40:43], v[24:39]
  ds_read_b128 v[40:43], v6 offset:512
  s_waitcnt lgkmcnt(3)
  v_mfma_f32_32x32x16_bf16 v[24:39], a[68:71], v[44:47], v[24:39]
  ds_read_b128 v[44:47], v7 offset:512
  s_mov_b32 m0, s44
  s_add_u32 s44, s44, 1024
  s_waitcnt lgkmcnt(3)
  v_mfma_f32_32x32x16_bf16 v[24:39], a[72:75], v[48:51], v[24:39]
  ds_read_b128 v[48:51], v8 offset:512
  buffer_load_dwordx4 v14, s[12:15], s45 offen lds
  s_add_u32 s45, s45, 1024
  s_waitcnt lgkmcnt(3)
  v_mfma_f32_32x32x16_bf16 v[24:39], a[76:79], v[52:55], v[24:39]
  ds_read_b128 v[52:55], v9 offset:512
  s_waitcnt lgkmcnt(3)
  v_mfma_f32_32x32x16_bf16 v[24:39], a[80:83], v[40:43], v[24:39]
  ds_read_b128 v[40:43], v2 offset:768
  s_waitcnt lgkmcnt(3)
  v_mfma_f32_32x32x16_bf16 v[24:39], a[84:87], v[44:47], v[24:39]
  ds_read_b128 v[44:47], v3 offset:768
  s_mov_b32 m0, s44
  s_add_u32 s44, s44, 1024
  s_waitcnt lgkmcnt(3)
  v_mfma_f32_32x32x16_bf16 v[24:39], a[88:91], v[48:51], v[24:39]
  ds_read_b128 v[48:51], v4 offset:768
  buffer_load_dwordx4 v15, s[12:15], s45 offen lds
  s_add_u32 s45, s45, 1024
  s_waitcnt lgkmcnt(3)
  v_mfma_f32_32x32x16_bf16 v[24:39], a[92:95], v[52:55], v[24:39]
  ds_read_b128 v[52:55], v5 offset:768
  s_waitcnt lgkmcnt(3)
  v_mfma_f32_32x32x16_bf16 v[24:39], a[96:99], v[40:43], v[24:39]
  ds_read_b128 v[40:43], v6 offset:768
  s_waitcnt lgkmcnt(3)
  v_mfma_f32_32x32x16_bf16 v[24:39], a[100:103], v[44:47], v[24:39]
  ds_read_b128 v[44:47], v7 offset:768
  s_mov_b32 m0, s44
  s_add_u32 s44, s44, 1024
  s_waitcnt lgkmcnt(3)
  v_mfma_f32_32x32x16_bf16 v[24:39], a[104:107], v[48:51], v[24:39]
  ds_read_b128 v[48:51], v8 offset:768
  buffer_load_dwordx4 v16, s[12:15], s45 offen lds
  s_add_u32 s45, s45, 1024
  s_waitcnt lgkmcnt(3)
  v_mfma_f32_32x32x16_bf16 v[24:39], a[108:111], v[52:55], v[24:39]
  ds_read_b128 v[52:55], v9 offset:768
  s_waitcnt lgkmcnt(3)
  v_mfma_f32_32x32x16_bf16 v[24:39], a[112:115], v[40:43], v[24:39]
  s_waitcnt lgkmcnt(2)
  v_mfma_f32_32x32x16_bf16 v[24:39], a[116:119], v[44:47], v[24:39]
  s_mov_b32 m0, s44
  s_add_u32 s44, s44, 1024
  s_waitcnt lgkmcnt(1)
  v_mfma_f32_32x32x16_bf16 v[24:39], a[120:123], v[48:51], v[24:39]
  buffer_load_dwordx4 v17, s[12:15], s45 offen lds
  s_add_u32 s45, s45, 1024
  s_waitcnt lgkmcnt(0)
  v_mfma_f32_32x32x16_bf16 v[24:39], a[124:127], v[52:55], v[24:39]
  s_branch GSM_SMJ
GSM_SMV:
  s_waitcnt lgkmcnt(3)
  v_mfma_f32_32x32x16_bf16 v[24:39], v[40:43], a[0:3], 0
  ds_read_b128 v[40:43], v6 offset:0
  s_waitcnt lgkmcnt(3)
  v_mfma_f32_32x32x16_bf16 v[24:39], v[44:47], a[4:7], v[24:39]
  ds_read_b128 v[44:47], v7 offset:0
  s_mov_b32 m0, s44
  s_add_u32 s44, s44, 1024
  s_waitcnt lgkmcnt(3)
  v_mfma_f32_32x32x16_bf16 v[24:39], v[48:51], a[8:11], v[24:39]
  ds_read_b128 v[48:51], v8 offset:0
  buffer_load_dwordx4 v10, s[12:15], s45 offen lds
  s_add_u32 s45, s45, 1024
  s_waitcnt lgkmcnt(3)
  v_mfma_f32_32x32x16_bf16 v[24:39], v[52:55], a[12:15], v[24:39]
  ds_read_b128 v[52:55], v9 offset:0
  s_waitcnt lgkmcnt(3)
  v_mfma_f32_32x32x16_bf16 v[24:39], v[40:43], a[16:19], v[24:39]
  ds_read_b128 v[40:43], v2 offset:256
  s_waitcnt lgkmcnt(3)
  v_mfma_f32_32x32x16_bf16 v[24:39], v[44:47], a[20:23], v[24:39]
  ds_read_b128 v[44:47], v3 offset:256
  s_mov_b32 m0, s44
  s_add_u32 s44, s44, 1024
  s_waitcnt lgkmcnt(3)
  v_mfma_f32_32x32x16_bf16 v[24:39], v[48:51], a[24:27], v[24:39]
  ds_read_b128 v[48:51], v4 offset:256
  buffer_load_dwordx4 v11, s[12:15], s45 offen lds
  s_add_u32 s45, s45, 1024
  s_waitcnt lgkmcnt(3)
  v_mfma_f32_32x32x16_bf16 v[24:39], v[52:55], a[28:31], v[24:39]
  ds_read_b128 v[52:55], v5 offset:256
  s_waitcnt lgkmcnt(3)
  v_mfma_f32_32x32x16_bf16 v[24:39], v[40:43], a[32:35], v[24:39]
  ds_read_b128 v[40:43], v6 offset:256
  s_waitcnt lgkmcnt(3)
  v_mfma_f32_32x32x16_bf16 v[24:39], v[44:47], a[36:39], v[24:39]
  ds_read_b128 v[44:47], v7 offset:256
  s_mov_b32 m0, s44
  s_add_u32 s44, s44, 1024
  s_waitcnt lgkmcnt(3)
  v_mfma_f32_32x32x16_bf16 v[24:39], v[48:51], a[40:43], v[24:39]
  ds_read_b128 v[48:51], v8 offset:256
  buffer_load_dwordx4 v12, s[12:15], s45 offen lds
  s_add_u32 s45, s45, 1024
  s_waitcnt lgkmcnt(3)
  v_mfma_f32_32x32x16_bf16 v[24:39], v[52:55], a[44:47], v[24:39]
  ds_read_b128 v[52:55], v9 offset:256
  s_waitcnt lgkmcnt(3)
  v_mfma_f32_32x32x16_bf16 v[24:39], v[40:43], a[48:51], v[24:39]
  ds_read_b128 v[40:43], v2 offset:512
  s_waitcnt lgkmcnt(3)
  v_mfma_f32_32x32x16_bf16 v[24:39], v[44:47], a[52:55], v[24:39]
  ds_read_b128 v[44:47], v3 offset:512
  s_mov_b32 m0, s44
  s_add_u32 s44, s44, 1024
  s_waitcnt lgkmcnt(3)
  v_mfma_f32_32x32x16_bf16 v[24:39], v[48:51], a[56:59], v[24:39]
  ds_read_b128 v[48:51], v4 offset:512
  buffer_load_dwordx4 v13, s[12:15], s45 offen lds
  s_add_u32 s45, s45, 1024
  s_waitcnt lgkmcnt(3)
  v_mfma_f32_32x32x16_bf16 v[24:39], v[52:55], a[60:63], v[24:39]
  ds_read_b128 v[52:55], v5 offset:512
  s_waitcnt lgkmcnt(3)
  v_mfma_f32_32x32x16_bf16 v[24:39], v[40:43], a[64:67], v[24:39]
  ds_read_b128 v[40:43], v6 offset:512
  s_waitcnt lgkmcnt(3)
  v_mfma_f32_32x32x16_bf16 v[24:39], v[44:47], a[68:71], v[24:39]
  ds_read_b128 v[44:47], v7 offset:512
  s_mov_b32 m0, s44
  s_add_u32 s44, s44, 1024
  s_waitcnt lgkmcnt(3)
  v_mfma_f32_32x32x16_bf16 v[24:39], v[48:51], a[72:75], v[24:39]
  ds_read_b128 v[48:51], v8 offset:512
  buffer_load_dwordx4 v14, s[12:15], s45 offen lds
  s_add_u32 s45, s45, 1024
  s_waitcnt lgkmcnt(3)
  v_mfma_f32_32x32x16_bf16 v[24:39], v[52:55], a[76:79], v[24:39]
  ds_read_b128 v[52:55], v9 offset:512
  s_waitcnt lgkmcnt(3)
  v_mfma_f32_32x32x16_bf16 v[24:39], v[40:43], a[80:83], v[24:39]
  ds_read_b128 v[40:43], v2 offset:768
  s_waitcnt lgkmcnt(3)
  v_mfma_f32_32x32x16_bf16 v[24:39], v[44:47], a[84:87], v[24:39]
  ds_read_b128 v[44:47], v3 offset:768
  s_mov_b32 m0, s44
  s_add_u32 s44, s44, 1024
  s_waitcnt lgkmcnt(3)
  v_mfma_f32_32x32x16_bf16 v[24:39], v[48:51], a[88:91], v[24:39]
  ds_read_b128 v[48:51], v4 offset:768
  buffer_load_dwordx4 v15, s[12:15], s45 offen lds
  s_add_u32 s45, s45, 1024
  s_waitcnt lgkmcnt(3)
  v_mfma_f32_32x32x16_bf16 v[24:39], v[52:55], a[92:95], v[24:39]
  ds_read_b128 v[52:55], v5 offset:768
  s_waitcnt lgkmcnt(3)
  v_mfma_f32_32x32x16_bf16 v[24:39], v[40:43], a[96:99], v[24:39]
  ds_read_b128 v[40:43], v6 offset:768
  s_waitcnt lgkmcnt(3)
  v_mfma_f32_32x32x16_bf16 v[24:39], v[44:47], a[100:103], v[24:39]
  ds_read_b128 v[44:47], v7 offset:768
  s_mov_b32 m0, s44
  s_add_u32 s44, s44, 1024
  s_waitcnt lgkmcnt(3)
  v_mfma_f32_32x32x16_bf16 v[24:39], v[48:51], a[104:107], v[24:39]
  ds_read_b128 v[48:51], v8 offset:768
  buffer_load_dwordx4 v16, s[12:15], s45 offen lds
  s_add_u32 s45, s45, 1024
  s_waitcnt lgkmcnt(3)
  v_mfma_f32_32x32x16_bf16 v[24:39], v[52:55], a[108:111], v[24:39]
  ds_read_b128 v[52:55], v9 offset:768
  s_waitcnt lgkmcnt(3)
  v_mfma_f32_32x32x16_bf16 v[24:39], v[40:43], a[112:115], v[24:39]
  s_waitcnt lgkmcnt(2)
  v_mfma_f32_32x32x16_bf16 v[24:39], v[44:47], a[116:119], v[24:39]
  s_mov_b32 m0, s44
  s_add_u32 s44, s44, 1024
  s_waitcnt lgkmcnt(1)
  v_mfma_f32_32x32x16_bf16 v[24:39], v[48:51], a[120:123], v[24:39]
  buffer_load_dwordx4 v17, s[12:15], s45 offen lds
  s_add_u32 s45, s45, 1024
  s_waitcnt lgkmcnt(0)
  v_mfma_f32_32x32x16_bf16 v[24:39], v[52:55], a[124:127], v[24:39]
GSM_SMJ:
  s_add_u32 s29, s29, 32768
  s_cmp_ge_u32 s29, 98304
  s_mov_b32 s40, 32768
  s_cselect_b32 s40, 4294901760, s40
  s_cselect_b32 s41, 0, s29
  s_mov_b32 s29, s41
  v_add_u32 v2, s40, v2
  v_add_u32 v3, s40, v3
  v_add_u32 v4, s40, v4
  v_add_u32 v5, s40, v5
  v_add_u32 v6, s40, v6
  v_add_u32 v7, s40, v7
  v_add_u32 v8, s40, v8
  v_add_u32 v9, s40, v9
  s_nop 3
  v_mul_f32 v20, 0xbfb8aa3b, v32
  v_exp_f32 v20, v20
  s_nop 0
  v_add_f32 v20, 1.0, v20
  v_rcp_f32 v20, v20
  v_cvt_pk_bf16_f32 v56, v24, v25
  v_cvt_pk_bf16_f32 v57, v26, v27
  v_cvt_pk_bf16_f32 v58, v28, v29
  v_cvt_pk_bf16_f32 v59, v30, v31
  v_cvt_pk_bf16_f32 v60, v32, v33
  v_cvt_pk_bf16_f32 v61, v34, v35
  v_cvt_pk_bf16_f32 v62, v36, v37
  v_cvt_pk_bf16_f32 v63, v38, v39
  s_mul_i32 s40, s24, s27
  s_add_u32 s40, s40, s26
  s_lshl_b32 s40, s24, 10
  s_cmp_eq_u32 s21, 1
  s_cbranch_scc1 GSM_STV
  s_cmp_eq_u32 s21, 0
  s_cbranch_scc0 GSM_STN
  s_add_u32 s41, s40, 65011712
  buffer_store_dwordx4 v[56:59], v1, s[8:11], s41 offen sc1
  s_lshl_b32 s41, s24, 7
  s_add_u32 s41, s41, 65142784
  v_lshlrev_b32 v21, 2, v0
  s_mov_b64 exec, 0xffffffff
  buffer_store_dword v20, v21, s[8:11], s41 offen sc1
  s_mov_b64 exec, -1
  s_branch GSM_STD
GSM_STV:
  s_add_u32 s41, s40, 65077248
  s_mov_b32 s42, 0x0000ffff
  s_mov_b32 s43, 0x0000ffff
  s_mov_b64 exec, s[42:43]
  buffer_store_dwordx4 v[56:59], v18, s[8:11], s41 offen sc1
  buffer_store_dwordx4 v[60:63], v18, s[8:11], s41 offen offset:512 sc1
  s_mov_b64 exec, -1
  s_branch GSM_STD
GSM_STN:
  s_waitcnt vmcnt(0)
GSM_STD:
  s_add_u32 s24, s24, s25
  s_add_u32 s22, s22, 1
  s_cmp_lt_u32 s22, s23
  s_cbranch_scc1 GSM_LOOP
  s_waitcnt vmcnt(0)
  s_barrier
  s_cmp_eq_u32 s21, 0
  s_cbranch_scc0 GSM_END
  v_mov_b32 v20, s23
  s_mov_b64 exec, 1
  buffer_store_dword v20, v19, s[8:11], s28 offen sc1
  s_mov_b64 exec, -1
  s_waitcnt vmcnt(0)
GSM_END:
  s_branch G_DONE
G_IDLE:
  s_waitcnt vmcnt(0)
  s_cmp_eq_u32 s63, 0
  s_cbranch_scc0 H5_SKIP
  s_cmp_eq_u32 s21, 0
  s_cbranch_scc0 H5_NOSIG
  s_mov_b64 exec, 1
  v_mov_b32 v23, 1
  v_mov_b32 v22, 36
  buffer_atomic_add v23, v22, s[56:59], 0 offen
  s_mov_b64 exec, -1
H5_NOSIG:
H5_SKIP:
G_DONE:
  v_bfe_u32 v10, v0, 1, 5
  v_lshlrev_b32 v200, 10, v10
  v_bfe_u32 v10, v0, 0, 1
  v_lshl_add_u32 v200, v10, 4, v200
  s_mov_b32 s48, s74
  s_and_b32 s49, s75, 0xffff
  s_mov_b32 s50, 0x400000
  s_mov_b32 s51, 0x20000
  s_mov_b32 s52, s82
  s_and_b32 s53, s83, 0xffff
  s_mov_b32 s54, 0x80000
  s_mov_b32 s55, 0x20000
  s_lshl_b32 s42, s21, 20
  s_lshl_b32 s41, s20, 5
  s_add_u32 s42, s42, s41
  s_lshl_b32 s43, s20, 15
  s_add_u32 s40, s42, s43
  buffer_load_dwordx4 a[0:3], v200, s[48:51], s40 offen
  s_add_u32 s43, s43, 32768
  s_and_b32 s43, s43, 0xfffff
  s_add_u32 s40, s42, s43
  buffer_load_dwordx4 a[4:7], v200, s[48:51], s40 offen
  s_add_u32 s43, s43, 32768
  s_and_b32 s43, s43, 0xfffff
  s_add_u32 s40, s42, s43
  buffer_load_dwordx4 a[8:11], v200, s[48:51], s40 offen
  s_add_u32 s43, s43, 32768
  s_and_b32 s43, s43, 0xfffff
  s_add_u32 s40, s42, s43
  buffer_load_dwordx4 a[12:15], v200, s[48:51], s40 offen
  s_add_u32 s43, s43, 32768
  s_and_b32 s43, s43, 0xfffff
  s_add_u32 s40, s42, s43
  buffer_load_dwordx4 a[16:19], v200, s[48:51], s40 offen
  s_add_u32 s43, s43, 32768
  s_and_b32 s43, s43, 0xfffff
  s_add_u32 s40, s42, s43
  buffer_load_dwordx4 a[20:23], v200, s[48:51], s40 offen
  s_add_u32 s43, s43, 32768
  s_and_b32 s43, s43, 0xfffff
  s_add_u32 s40, s42, s43
  buffer_load_dwordx4 a[24:27], v200, s[48:51], s40 offen
  s_add_u32 s43, s43, 32768
  s_and_b32 s43, s43, 0xfffff
  s_add_u32 s40, s42, s43
  buffer_load_dwordx4 a[28:31], v200, s[48:51], s40 offen
  s_add_u32 s43, s43, 32768
  s_and_b32 s43, s43, 0xfffff
  s_add_u32 s40, s42, s43
  buffer_load_dwordx4 a[32:35], v200, s[48:51], s40 offen
  s_add_u32 s43, s43, 32768
  s_and_b32 s43, s43, 0xfffff
  s_add_u32 s40, s42, s43
  buffer_load_dwordx4 a[36:39], v200, s[48:51], s40 offen
  s_add_u32 s43, s43, 32768
  s_and_b32 s43, s43, 0xfffff
  s_add_u32 s40, s42, s43
  buffer_load_dwordx4 a[40:43], v200, s[48:51], s40 offen
  s_add_u32 s43, s43, 32768
  s_and_b32 s43, s43, 0xfffff
  s_add_u32 s40, s42, s43
  buffer_load_dwordx4 a[44:47], v200, s[48:51], s40 offen
  s_add_u32 s43, s43, 32768
  s_and_b32 s43, s43, 0xfffff
  s_add_u32 s40, s42, s43
  buffer_load_dwordx4 a[48:51], v200, s[48:51], s40 offen
  s_add_u32 s43, s43, 32768
  s_and_b32 s43, s43, 0xfffff
  s_add_u32 s40, s42, s43
  buffer_load_dwordx4 a[52:55], v200, s[48:51], s40 offen
  s_add_u32 s43, s43, 32768
  s_and_b32 s43, s43, 0xfffff
  s_add_u32 s40, s42, s43
  buffer_load_dwordx4 a[56:59], v200, s[48:51], s40 offen
  s_add_u32 s43, s43, 32768
  s_and_b32 s43, s43, 0xfffff
  s_add_u32 s40, s42, s43
  buffer_load_dwordx4 a[60:63], v200, s[48:51], s40 offen
  s_add_u32 s43, s43, 32768
  s_and_b32 s43, s43, 0xfffff
  s_add_u32 s40, s42, s43
  buffer_load_dwordx4 a[64:67], v200, s[48:51], s40 offen
  s_add_u32 s43, s43, 32768
  s_and_b32 s43, s43, 0xfffff
  s_add_u32 s40, s42, s43
  buffer_load_dwordx4 a[68:71], v200, s[48:51], s40 offen
  s_add_u32 s43, s43, 32768
  s_and_b32 s43, s43, 0xfffff
  s_add_u32 s40, s42, s43
  buffer_load_dwordx4 a[72:75], v200, s[48:51], s40 offen
  s_add_u32 s43, s43, 32768
  s_and_b32 s43, s43, 0xfffff
  s_add_u32 s40, s42, s43
  buffer_load_dwordx4 a[76:79], v200, s[48:51], s40 offen
  s_add_u32 s43, s43, 32768
  s_and_b32 s43, s43, 0xfffff
  s_add_u32 s40, s42, s43
  buffer_load_dwordx4 a[80:83], v200, s[48:51], s40 offen
  s_add_u32 s43, s43, 32768
  s_and_b32 s43, s43, 0xfffff
  s_add_u32 s40, s42, s43
  buffer_load_dwordx4 a[84:87], v200, s[48:51], s40 offen
  s_add_u32 s43, s43, 32768
  s_and_b32 s43, s43, 0xfffff
  s_add_u32 s40, s42, s43
  buffer_load_dwordx4 a[88:91], v200, s[48:51], s40 offen
  s_add_u32 s43, s43, 32768
  s_and_b32 s43, s43, 0xfffff
  s_add_u32 s40, s42, s43
  buffer_load_dwordx4 a[92:95], v200, s[48:51], s40 offen
  s_add_u32 s43, s43, 32768
  s_and_b32 s43, s43, 0xfffff
  s_add_u32 s40, s42, s43
  buffer_load_dwordx4 a[96:99], v200, s[48:51], s40 offen
  s_add_u32 s43, s43, 32768
  s_and_b32 s43, s43, 0xfffff
  s_add_u32 s40, s42, s43
  buffer_load_dwordx4 a[100:103], v200, s[48:51], s40 offen
  s_add_u32 s43, s43, 32768
  s_and_b32 s43, s43, 0xfffff
  s_add_u32 s40, s42, s43
  buffer_load_dwordx4 a[104:107], v200, s[48:51], s40 offen
  s_add_u32 s43, s43, 32768
  s_and_b32 s43, s43, 0xfffff
  s_add_u32 s40, s42, s43
  buffer_load_dwordx4 a[108:111], v200, s[48:51], s40 offen
  s_add_u32 s43, s43, 32768
  s_and_b32 s43, s43, 0xfffff
  s_add_u32 s40, s42, s43
  buffer_load_dwordx4 a[112:115], v200, s[48:51], s40 offen
  s_add_u32 s43, s43, 32768
  s_and_b32 s43, s43, 0xfffff
  s_add_u32 s40, s42, s43
  buffer_load_dwordx4 a[116:119], v200, s[48:51], s40 offen
  s_add_u32 s43, s43, 32768
  s_and_b32 s43, s43, 0xfffff
  s_add_u32 s40, s42, s43
  buffer_load_dwordx4 a[120:123], v200, s[48:51], s40 offen
  s_add_u32 s43, s43, 32768
  s_and_b32 s43, s43, 0xfffff
  s_add_u32 s40, s42, s43
  buffer_load_dwordx4 a[124:127], v200, s[48:51], s40 offen
  s_add_u32 s43, s43, 32768
  s_and_b32 s43, s43, 0xfffff
  s_lshl_b32 s40, s21, 17
  s_add_u32 s40, s40, s41
  buffer_load_dwordx4 a[128:131], v200, s[52:55], s40 offen
  s_add_u32 s40, s40, 32768
  buffer_load_dwordx4 a[132:135], v200, s[52:55], s40 offen
  s_add_u32 s40, s40, 32768
  buffer_load_dwordx4 a[136:139], v200, s[52:55], s40 offen
  s_add_u32 s40, s40, 32768
  buffer_load_dwordx4 a[140:143], v200, s[52:55], s40 offen
  s_add_u32 s40, s40, 32768
  s_mov_b32 s16, s88
  s_and_b32 s17, s89, 0xffff
  s_mov_b32 s18, 0x100
  s_mov_b32 s19, 0x20000
  s_mov_b32 s28, 0
  v_mov_b32 v4, 36
K_WI:
  buffer_load_dword v5, v4, s[16:19], 0 offen sc1
  s_add_u32 s28, s28, 1
  s_cmp_gt_u32 s28, 4000000
  s_cbranch_scc1 K_ABORT
  s_waitcnt vmcnt(0)
  v_mov_b32 v6, 256
  v_cmp_gt_u32 vcc, v6, v5
  s_cbranch_vccnz K_WI
  s_barrier
  v_lshlrev_b32 v1, 4, v0
  v_bfe_u32 v4, v0, 5, 1
  v_lshlrev_b32 v2, 8, v4
  v_bfe_u32 v4, v0, 0, 4
  v_lshl_add_u32 v2, v4, 4, v2
  v_add_u32 v2, 65536, v2
  v_bfe_u32 v4, v0, 4, 1
  v_lshlrev_b32 v3, 10, v4
  v_bfe_u32 v4, v0, 5, 1
  v_lshl_add_u32 v3, v4, 8, v3
  v_bfe_u32 v4, v0, 0, 4
  v_lshl_add_u32 v3, v4, 4, v3
  s_mov_b32 s48, 0x0000ffff
  s_mov_b32 s49, 0x0000ffff
  v_and_b32 v4, 27, v0
  v_cmp_eq_u32 vcc, 16, v4
  v_mov_b32 v5, 0x3f803f80
  v_mov_b32 v4, 0
  v_cndmask_b32 v4, v4, v5, vcc
  v_mov_b32 v20, v4
  v_mov_b32 v21, v4
  v_mov_b32 v22, v4
  v_mov_b32 v23, v4
  v_mov_b32 v24, v4
  v_mov_b32 v25, v4
  v_mov_b32 v26, v4
  v_mov_b32 v27, v4
  v_mov_b32 v28, v4
  v_mov_b32 v29, v4
  v_mov_b32 v30, v4
  v_mov_b32 v31, v4
  v_mov_b32 v32, v4
  v_mov_b32 v33, v4
  v_mov_b32 v34, v4
  v_mov_b32 v35, v4
  s_mov_b32 s40, 66086912
  s_mov_b32 s28, 0
  v_mov_b32 v5, 0
BW0_WF:
  buffer_load_dword v4, v5, s[8:11], s40 offen sc1
  s_add_u32 s28, s28, 1
  s_cmp_gt_u32 s28, 4000000
  s_cbranch_scc1 K_ABORT
  s_waitcnt vmcnt(0)
  v_cmp_gt_u32 vcc, 8, v4
  s_cbranch_vccz BW0_WFD
  s_sleep 8
  s_branch BW0_WF
BW0_WFD:
  s_mov_b32 s40, 66087040
  s_mov_b32 s28, 0
  v_mov_b32 v5, 0
BW1_WF:
  buffer_load_dword v4, v5, s[8:11], s40 offen sc1
  s_add_u32 s28, s28, 1
  s_cmp_gt_u32 s28, 4000000
  s_cbranch_scc1 K_ABORT
  s_waitcnt vmcnt(0)
  v_cmp_gt_u32 vcc, 8, v4
  s_cbranch_vccz BW1_WFD
  s_sleep 8
  s_branch BW1_WF
BW1_WFD:
  s_mov_b32 s40, 66087168
  s_mov_b32 s28, 0
  v_mov_b32 v5, 0
BW2_WF:
  buffer_load_dword v4, v5, s[8:11], s40 offen sc1
  s_add_u32 s28, s28, 1
  s_cmp_gt_u32 s28, 4000000
  s_cbranch_scc1 K_ABORT
  s_waitcnt vmcnt(0)
  v_cmp_gt_u32 vcc, 8, v4
  s_cbranch_vccz BW2_WFD
  s_sleep 8
  s_branch BW2_WF
BW2_WFD:
  s_mov_b32 s40, 66087296
  s_mov_b32 s28, 0
  v_mov_b32 v5, 0
BW3_WF:
  buffer_load_dword v4, v5, s[8:11], s40 offen sc1
  s_add_u32 s28, s28, 1
  s_cmp_gt_u32 s28, 4000000
  s_cbranch_scc1 K_ABORT
  s_waitcnt vmcnt(0)
  v_cmp_gt_u32 vcc, 8, v4
  s_cbranch_vccz BW3_WFD
  s_sleep 8
  s_branch BW3_WF
BW3_WFD:
  s_mov_b32 s40, 66087424
  s_mov_b32 s28, 0
  v_mov_b32 v5, 0
BW4_WF:
  buffer_load_dword v4, v5, s[8:11], s40 offen sc1
  s_add_u32 s28, s28, 1
  s_cmp_gt_u32 s28, 4000000
  s_cbranch_scc1 K_ABORT
  s_waitcnt vmcnt(0)
  v_cmp_gt_u32 vcc, 8, v4
  s_cbranch_vccz BW4_WFD
  s_sleep 8
  s_branch BW4_WF
BW4_WFD:
  s_mov_b32 s40, 66087552
  s_mov_b32 s28, 0
  v_mov_b32 v5, 0
BW5_WF:
  buffer_load_dword v4, v5, s[8:11], s40 offen sc1
  s_add_u32 s28, s28, 1
  s_cmp_gt_u32 s28, 4000000
  s_cbranch_scc1 K_ABORT
  s_waitcnt vmcnt(0)
  v_cmp_gt_u32 vcc, 8, v4
  s_cbranch_vccz BW5_WFD
  s_sleep 8
  s_branch BW5_WF
BW5_WFD:
  s_mov_b32 s40, 66087680
  s_mov_b32 s28, 0
  v_mov_b32 v5, 0
BW6_WF:
  buffer_load_dword v4, v5, s[8:11], s40 offen sc1
  s_add_u32 s28, s28, 1
  s_cmp_gt_u32 s28, 4000000
  s_cbranch_scc1 K_ABORT
  s_waitcnt vmcnt(0)
  v_cmp_gt_u32 vcc, 8, v4
  s_cbranch_vccz BW6_WFD
  s_sleep 8
  s_branch BW6_WF
BW6_WFD:
  s_mov_b32 s40, 66087808
  s_mov_b32 s28, 0
  v_mov_b32 v5, 0
BW7_WF:
  buffer_load_dword v4, v5, s[8:11], s40 offen sc1
  s_add_u32 s28, s28, 1
  s_cmp_gt_u32 s28, 4000000
  s_cbranch_scc1 K_ABORT
  s_waitcnt vmcnt(0)
  v_cmp_gt_u32 vcc, 8, v4
  s_cbranch_vccz BW7_WFD
  s_sleep 8
  s_branch BW7_WF
BW7_WFD:
  s_lshl_b32 s40, s21, 15
  s_lshl_b32 s42, s20, 10
  s_add_u32 s43, s40, s42
  s_mov_b32 m0, s43
  s_add_u32 s41, s43, 65011712
  buffer_load_dwordx4 v1, s[8:11], s41 offen lds
  s_add_u32 s42, s42, 1024
  s_and_b32 s42, s42, 0x7fff
  s_add_u32 s43, s40, s42
  s_mov_b32 m0, s43
  s_add_u32 s41, s43, 65011712
  buffer_load_dwordx4 v1, s[8:11], s41 offen lds
  s_add_u32 s42, s42, 1024
  s_and_b32 s42, s42, 0x7fff
  s_add_u32 s43, s40, s42
  s_mov_b32 m0, s43
  s_add_u32 s41, s43, 65011712
  buffer_load_dwordx4 v1, s[8:11], s41 offen lds
  s_add_u32 s42, s42, 1024
  s_and_b32 s42, s42, 0x7fff
  s_add_u32 s43, s40, s42
  s_mov_b32 m0, s43
  s_add_u32 s41, s43, 65011712
  buffer_load_dwordx4 v1, s[8:11], s41 offen lds
  s_add_u32 s42, s42, 1024
  s_and_b32 s42, s42, 0x7fff
  s_add_u32 s43, s40, s42
  s_mov_b32 m0, s43
  s_add_u32 s41, s43, 65011712
  buffer_load_dwordx4 v1, s[8:11], s41 offen lds
  s_add_u32 s42, s42, 1024
  s_and_b32 s42, s42, 0x7fff
  s_add_u32 s43, s40, s42
  s_mov_b32 m0, s43
  s_add_u32 s41, s43, 65011712
  buffer_load_dwordx4 v1, s[8:11], s41 offen lds
  s_add_u32 s42, s42, 1024
  s_and_b32 s42, s42, 0x7fff
  s_add_u32 s43, s40, s42
  s_mov_b32 m0, s43
  s_add_u32 s41, s43, 65011712
  buffer_load_dwordx4 v1, s[8:11], s41 offen lds
  s_add_u32 s42, s42, 1024
  s_and_b32 s42, s42, 0x7fff
  s_add_u32 s43, s40, s42
  s_mov_b32 m0, s43
  s_add_u32 s41, s43, 65011712
  buffer_load_dwordx4 v1, s[8:11], s41 offen lds
  s_add_u32 s42, s42, 1024
  s_and_b32 s42, s42, 0x7fff
  s_add_u32 s43, s40, s42
  s_mov_b32 m0, s43
  s_add_u32 s41, s43, 65011712
  buffer_load_dwordx4 v1, s[8:11], s41 offen lds
  s_add_u32 s42, s42, 1024
  s_and_b32 s42, s42, 0x7fff
  s_add_u32 s43, s40, s42
  s_mov_b32 m0, s43
  s_add_u32 s41, s43, 65011712
  buffer_load_dwordx4 v1, s[8:11], s41 offen lds
  s_add_u32 s42, s42, 1024
  s_and_b32 s42, s42, 0x7fff
  s_add_u32 s43, s40, s42
  s_mov_b32 m0, s43
  s_add_u32 s41, s43, 65011712
  buffer_load_dwordx4 v1, s[8:11], s41 offen lds
  s_add_u32 s42, s42, 1024
  s_and_b32 s42, s42, 0x7fff
  s_add_u32 s43, s40, s42
  s_mov_b32 m0, s43
  s_add_u32 s41, s43, 65011712
  buffer_load_dwordx4 v1, s[8:11], s41 offen lds
  s_add_u32 s42, s42, 1024
  s_and_b32 s42, s42, 0x7fff
  s_add_u32 s43, s40, s42
  s_mov_b32 m0, s43
  s_add_u32 s41, s43, 65011712
  buffer_load_dwordx4 v1, s[8:11], s41 offen lds
  s_add_u32 s42, s42, 1024
  s_and_b32 s42, s42, 0x7fff
  s_add_u32 s43, s40, s42
  s_mov_b32 m0, s43
  s_add_u32 s41, s43, 65011712
  buffer_load_dwordx4 v1, s[8:11], s41 offen lds
  s_add_u32 s42, s42, 1024
  s_and_b32 s42, s42, 0x7fff
  s_add_u32 s43, s40, s42
  s_mov_b32 m0, s43
  s_add_u32 s41, s43, 65011712
  buffer_load_dwordx4 v1, s[8:11], s41 offen lds
  s_add_u32 s42, s42, 1024
  s_and_b32 s42, s42, 0x7fff
  s_add_u32 s43, s40, s42
  s_mov_b32 m0, s43
  s_add_u32 s41, s43, 65011712
  buffer_load_dwordx4 v1, s[8:11], s41 offen lds
  s_add_u32 s42, s42, 1024
  s_and_b32 s42, s42, 0x7fff
  s_add_u32 s43, s40, s42
  s_mov_b32 m0, s43
  s_add_u32 s41, s43, 65011712
  buffer_load_dwordx4 v1, s[8:11], s41 offen lds
  s_add_u32 s42, s42, 1024
  s_and_b32 s42, s42, 0x7fff
  s_add_u32 s43, s40, s42
  s_mov_b32 m0, s43
  s_add_u32 s41, s43, 65011712
  buffer_load_dwordx4 v1, s[8:11], s41 offen lds
  s_add_u32 s42, s42, 1024
  s_and_b32 s42, s42, 0x7fff
  s_add_u32 s43, s40, s42
  s_mov_b32 m0, s43
  s_add_u32 s41, s43, 65011712
  buffer_load_dwordx4 v1, s[8:11], s41 offen lds
  s_add_u32 s42, s42, 1024
  s_and_b32 s42, s42, 0x7fff
  s_add_u32 s43, s40, s42
  s_mov_b32 m0, s43
  s_add_u32 s41, s43, 65011712
  buffer_load_dwordx4 v1, s[8:11], s41 offen lds
  s_add_u32 s42, s42, 1024
  s_and_b32 s42, s42, 0x7fff
  s_add_u32 s43, s40, s42
  s_mov_b32 m0, s43
  s_add_u32 s41, s43, 65011712
  buffer_load_dwordx4 v1, s[8:11], s41 offen lds
  s_add_u32 s42, s42, 1024
  s_and_b32 s42, s42, 0x7fff
  s_add_u32 s43, s40, s42
  s_mov_b32 m0, s43
  s_add_u32 s41, s43, 65011712
  buffer_load_dwordx4 v1, s[8:11], s41 offen lds
  s_add_u32 s42, s42, 1024
  s_and_b32 s42, s42, 0x7fff
  s_add_u32 s43, s40, s42
  s_mov_b32 m0, s43
  s_add_u32 s41, s43, 65011712
  buffer_load_dwordx4 v1, s[8:11], s41 offen lds
  s_add_u32 s42, s42, 1024
  s_and_b32 s42, s42, 0x7fff
  s_add_u32 s43, s40, s42
  s_mov_b32 m0, s43
  s_add_u32 s41, s43, 65011712
  buffer_load_dwordx4 v1, s[8:11], s41 offen lds
  s_add_u32 s42, s42, 1024
  s_and_b32 s42, s42, 0x7fff
  s_add_u32 s43, s40, s42
  s_mov_b32 m0, s43
  s_add_u32 s41, s43, 65011712
  buffer_load_dwordx4 v1, s[8:11], s41 offen lds
  s_add_u32 s42, s42, 1024
  s_and_b32 s42, s42, 0x7fff
  s_add_u32 s43, s40, s42
  s_mov_b32 m0, s43
  s_add_u32 s41, s43, 65011712
  buffer_load_dwordx4 v1, s[8:11], s41 offen lds
  s_add_u32 s42, s42, 1024
  s_and_b32 s42, s42, 0x7fff
  s_add_u32 s43, s40, s42
  s_mov_b32 m0, s43
  s_add_u32 s41, s43, 65011712
  buffer_load_dwordx4 v1, s[8:11], s41 offen lds
  s_add_u32 s42, s42, 1024
  s_and_b32 s42, s42, 0x7fff
  s_add_u32 s43, s40, s42
  s_mov_b32 m0, s43
  s_add_u32 s41, s43, 65011712
  buffer_load_dwordx4 v1, s[8:11], s41 offen lds
  s_add_u32 s42, s42, 1024
  s_and_b32 s42, s42, 0x7fff
  s_add_u32 s43, s40, s42
  s_mov_b32 m0, s43
  s_add_u32 s41, s43, 65011712
  buffer_load_dwordx4 v1, s[8:11], s41 offen lds
  s_add_u32 s42, s42, 1024
  s_and_b32 s42, s42, 0x7fff
  s_add_u32 s43, s40, s42
  s_mov_b32 m0, s43
  s_add_u32 s41, s43, 65011712
  buffer_load_dwordx4 v1, s[8:11], s41 offen lds
  s_add_u32 s42, s42, 1024
  s_and_b32 s42, s42, 0x7fff
  s_add_u32 s43, s40, s42
  s_mov_b32 m0, s43
  s_add_u32 s41, s43, 65011712
  buffer_load_dwordx4 v1, s[8:11], s41 offen lds
  s_add_u32 s42, s42, 1024
  s_and_b32 s42, s42, 0x7fff
  s_add_u32 s43, s40, s42
  s_mov_b32 m0, s43
  s_add_u32 s41, s43, 65011712
  buffer_load_dwordx4 v1, s[8:11], s41 offen lds
  s_add_u32 s42, s42, 1024
  s_and_b32 s42, s42, 0x7fff
  s_waitcnt vmcnt(0)
B_NEXT:
  s_barrier
  s_cmp_eq_u32 s21, 0
  s_cbranch_scc0 B_TK
  s_mov_b64 exec, 1
  v_mov_b32 v4, 40
  v_mov_b32 v5, 1
  buffer_atomic_add v5, v4, s[16:19], 0 offen sc0
  v_mov_b32 v4, 131072
  s_waitcnt vmcnt(0)
  ds_write_b32 v4, v5
  s_waitcnt lgkmcnt(0)
  s_mov_b64 exec, -1
B_TK:
  s_barrier
  v_mov_b32 v4, 131072
  ds_read_b32 v5, v4
  s_waitcnt lgkmcnt(0)
  v_readfirstlane_b32 s24, v5
  s_nop 3
  s_cmp_ge_u32 s24, 512
  s_cbranch_scc1 B_DONE
  s_lshr_b32 s25, s24, 3
  s_and_b32 s26, s24, 7
  s_lshl_b32 s26, s26, 2
  s_add_u32 s26, s26, s21
  s_lshr_b32 s40, s25, 4
  s_lshl_b32 s40, s40, 2
  s_lshr_b32 s41, s26, 3
  s_add_u32 s40, s40, s41
  s_lshl_b32 s40, s40, 7
  s_add_u32 s40, s40, 66084864
  s_and_b32 s41, s25, 15
  s_add_u32 s41, s41, 1
  s_mov_b32 s28, 0
  v_mov_b32 v5, 0
BWQ_WF:
  buffer_load_dword v4, v5, s[8:11], s40 offen sc1
  s_add_u32 s28, s28, 1
  s_cmp_gt_u32 s28, 4000000
  s_cbranch_scc1 K_ABORT
  s_waitcnt vmcnt(0)
  v_cmp_gt_u32 vcc, s41, v4
  s_cbranch_vccz BWQ_WFD
  s_sleep 8
  s_branch BWQ_WF
BWQ_WFD:
  s_lshl_b32 s40, s25, 5
  s_add_u32 s40, s40, s26
  s_lshl_b32 s40, s40, 10
  s_add_u32 s40, s40, 62914560
  buffer_load_dwordx4 v[8:11], v1, s[8:11], s40 offen sc1
  s_lshl_b32 s40, s25, 7
  s_add_u32 s40, s40, 65142784
  v_and_b32 v4, 31, v0
  v_lshlrev_b32 v4, 2, v4
  buffer_load_dword v98, v4, s[8:11], s40 offen sc1
  v_mov_b32 v6, v1
  v_mov_b32 v7, v2
  ds_read_b128 v[12:15], v6 offset:0
  ds_read_b128 v[16:19], v6 offset:1024
  v_mov_b64 v[80:81], 0
  v_mov_b64 v[82:83], 0
  v_mov_b64 v[84:85], 0
  v_mov_b64 v[86:87], 0
  v_mov_b64 v[88:89], 0
  v_mov_b64 v[90:91], 0
  v_mov_b64 v[92:93], 0
  v_mov_b64 v[94:95], 0
  s_waitcnt vmcnt(0) lgkmcnt(1)
  v_mfma_f32_32x32x16_bf16 v[48:63], v[12:15], v[8:11], 0
  s_nop 7
  s_mov_b64 exec, s[48:49]
  ds_read_b128 v[20:23], v7 offset:0
  ds_read_b128 v[24:27], v7 offset:512
  s_mov_b64 exec, -1
  s_waitcnt lgkmcnt(2)
  v_mfma_f32_32x32x16_bf16 v[64:79], v[16:19], v[8:11], 0
  ds_read_b128 v[12:15], v6 offset:2048
  v_exp_f32 v48, v48
  v_exp_f32 v49, v49
  v_exp_f32 v50, v50
  v_exp_f32 v51, v51
  v_exp_f32 v52, v52
  v_exp_f32 v53, v53
  v_exp_f32 v54, v54
  v_exp_f32 v55, v55
  v_exp_f32 v56, v56
  v_exp_f32 v57, v57
  v_exp_f32 v58, v58
  v_exp_f32 v59, v59
  v_exp_f32 v60, v60
  v_exp_f32 v61, v61
  v_exp_f32 v62, v62
  v_exp_f32 v63, v63
  v_cvt_pk_bf16_f32 v36, v48, v49
  v_cvt_pk_bf16_f32 v37, v50, v51
  v_cvt_pk_bf16_f32 v38, v52, v53
  v_cvt_pk_bf16_f32 v39, v54, v55
  v_cvt_pk_bf16_f32 v40, v56, v57
  v_cvt_pk_bf16_f32 v41, v58, v59
  v_cvt_pk_bf16_f32 v42, v60, v61
  v_cvt_pk_bf16_f32 v43, v62, v63
  s_mov_b32 s27, 1
B_LOOP:
  s_mov_b64 exec, s[48:49]
  ds_read_b128 v[28:31], v7 offset:1024
  ds_read_b128 v[32:35], v7 offset:1536
  s_mov_b64 exec, -1
  s_waitcnt lgkmcnt(2)
  v_mfma_f32_32x32x16_bf16 v[48:63], v[12:15], v[8:11], 0
  ds_read_b128 v[16:19], v6 offset:3072
  v_exp_f32 v64, v64
  v_exp_f32 v65, v65
  v_exp_f32 v66, v66
  v_exp_f32 v67, v67
  v_exp_f32 v68, v68
  v_mfma_f32_32x32x16_bf16 v[80:95], v[20:23], v[36:39], v[80:95]
  v_exp_f32 v69, v69
  v_exp_f32 v70, v70
  v_exp_f32 v71, v71
  v_exp_f32 v72, v72
  v_exp_f32 v73, v73
  v_exp_f32 v74, v74
  v_mfma_f32_32x32x16_bf16 v[80:95], v[24:27], v[40:43], v[80:95]
  v_exp_f32 v75, v75
  v_exp_f32 v76, v76
  v_exp_f32 v77, v77
  v_exp_f32 v78, v78
  v_exp_f32 v79, v79
  v_cvt_pk_bf16_f32 v36, v64, v65
  v_cvt_pk_bf16_f32 v37, v66, v67
  v_cvt_pk_bf16_f32 v38, v68, v69
  v_cvt_pk_bf16_f32 v39, v70, v71
  v_cvt_pk_bf16_f32 v40, v72, v73
  v_cvt_pk_bf16_f32 v41, v74, v75
  v_cvt_pk_bf16_f32 v42, v76, v77
  v_cvt_pk_bf16_f32 v43, v78, v79
  s_mov_b64 exec, s[48:49]
  ds_read_b128 v[20:23], v7 offset:2048
  ds_read_b128 v[24:27], v7 offset:2560
  s_mov_b64 exec, -1
  s_waitcnt lgkmcnt(2)
  v_mfma_f32_32x32x16_bf16 v[64:79], v[16:19], v[8:11], 0
  ds_read_b128 v[12:15], v6 offset:4096
  v_exp_f32 v48, v48
  v_exp_f32 v49, v49
  v_exp_f32 v50, v50
  v_exp_f32 v51, v51
  v_exp_f32 v52, v52
  v_mfma_f32_32x32x16_bf16 v[80:95], v[28:31], v[36:39], v[80:95]
  v_exp_f32 v53, v53
  v_exp_f32 v54, v54
  v_exp_f32 v55, v55
  v_exp_f32 v56, v56
  v_exp_f32 v57, v57
  v_exp_f32 v58, v58
  v_mfma_f32_32x32x16_bf16 v[80:95], v[32:35], v[40:43], v[80:95]
  v_exp_f32 v59, v59
  v_exp_f32 v60, v60
  v_exp_f32 v61, v61
  v_exp_f32 v62, v62
  v_exp_f32 v63, v63
  v_cvt_pk_bf16_f32 v36, v48, v49
  v_cvt_pk_bf16_f32 v37, v50, v51
  v_cvt_pk_bf16_f32 v38, v52, v53
  v_cvt_pk_bf16_f32 v39, v54, v55
  v_cvt_pk_bf16_f32 v40, v56, v57
  v_cvt_pk_bf16_f32 v41, v58, v59
  v_cvt_pk_bf16_f32 v42, v60, v61
  v_cvt_pk_bf16_f32 v43, v62, v63
  v_add_u32 v6, 2048, v6
  v_add_u32 v7, 2048, v7
  s_add_u32 s27, s27, 2
  s_cmp_lt_u32 s27, 63
  s_cbranch_scc1 B_LOOP
  s_mov_b64 exec, s[48:49]
  ds_read_b128 v[28:31], v7 offset:1024
  ds_read_b128 v[32:35], v7 offset:1536
  s_mov_b64 exec, -1
  s_waitcnt lgkmcnt(2)
  v_exp_f32 v64, v64
  v_exp_f32 v65, v65
  v_exp_f32 v66, v66
  v_exp_f32 v67, v67
  v_exp_f32 v68, v68
  v_mfma_f32_32x32x16_bf16 v[80:95], v[20:23], v[36:39], v[80:95]
  v_exp_f32 v69, v69
  v_exp_f32 v70, v70
  v_exp_f32 v71, v71
  v_exp_f32 v72, v72
  v_exp_f32 v73, v73
  v_exp_f32 v74, v74
  v_mfma_f32_32x32x16_bf16 v[80:95], v[24:27], v[40:43], v[80:95]
  v_exp_f32 v75, v75
  v_exp_f32 v76, v76
  v_exp_f32 v77, v77
  v_exp_f32 v78, v78
  v_exp_f32 v79, v79
  v_cvt_pk_bf16_f32 v36, v64, v65
  v_cvt_pk_bf16_f32 v37, v66, v67
  v_cvt_pk_bf16_f32 v38, v68, v69
  v_cvt_pk_bf16_f32 v39, v70, v71
  v_cvt_pk_bf16_f32 v40, v72, v73
  v_cvt_pk_bf16_f32 v41, v74, v75
  v_cvt_pk_bf16_f32 v42, v76, v77
  v_cvt_pk_bf16_f32 v43, v78, v79
  s_waitcnt lgkmcnt(0)
  v_mfma_f32_32x32x16_bf16 v[80:95], v[28:31], v[36:39], v[80:95]
  v_mfma_f32_32x32x16_bf16 v[80:95], v[32:35], v[40:43], v[80:95]
  s_nop 7
  s_nop 7
  v_max3_f32 v4, |v80|, |v81|, |v82|
  v_max3_f32 v5, |v83|, |v84|, |v85|
  v_max3_f32 v4, v4, |v86|, |v87|
  v_max_f32 v4, v4, v5
  s_mov_b32 s40, 0x5f800000
  s_mov_b32 s41, 0x1f800000
  s_mov_b32 s42, 0x7f800000
  v_cmp_nge_f32 s[44:45], s40, v88
  v_cmp_nle_f32 vcc, s41, v88
  s_nop 3
  s_or_b64 s[44:45], s[44:45], vcc
  v_mov_b32 v5, s42
  v_cmp_nlt_f32 vcc, v4, v5
  s_nop 3
  s_or_b64 vcc, vcc, s[44:45]
  s_cbranch_vccz B_OK
  v_mov_b64 v[80:81], 0
  v_mov_b64 v[82:83], 0
  v_mov_b64 v[84:85], 0
  v_mov_b64 v[86:87], 0
  v_mov_b64 v[88:89], 0
  v_mov_b64 v[90:91], 0
  v_mov_b64 v[92:93], 0
  v_mov_b64 v[94:95], 0
  v_mov_b32 v96, 0xff800000
  v_mov_b32 v6, v1
  v_mov_b32 v7, v2
  s_mov_b32 s27, 0
B_FB:
  ds_read_b128 v[12:15], v6 offset:0
  s_mov_b64 exec, s[48:49]
  ds_read_b128 v[20:23], v7 offset:0
  ds_read_b128 v[24:27], v7 offset:512
  s_mov_b64 exec, -1
  s_waitcnt lgkmcnt(0)
  v_mfma_f32_32x32x16_bf16 v[48:63], v[12:15], v[8:11], 0
  s_nop 7
  s_nop 7
  v_max3_f32 v4, v48, v49, v96
  v_max3_f32 v4, v4, v50, v51
  v_max3_f32 v4, v4, v52, v53
  v_max3_f32 v4, v4, v54, v55
  v_max3_f32 v4, v4, v56, v57
  v_max3_f32 v4, v4, v58, v59
  v_max3_f32 v4, v4, v60, v61
  v_max3_f32 v4, v4, v62, v63
  v_mov_b32 v5, v4
  s_nop 1
  v_permlane32_swap_b32 v4, v5
  s_nop 0
  v_max_f32 v4, v4, v5
  v_sub_f32 v97, v96, v4
  v_exp_f32 v97, v97
  v_mov_b32 v96, v4
  v_sub_f32 v48, v48, v4
  v_sub_f32 v49, v49, v4
  v_sub_f32 v50, v50, v4
  v_sub_f32 v51, v51, v4
  v_sub_f32 v52, v52, v4
  v_sub_f32 v53, v53, v4
  v_sub_f32 v54, v54, v4
  v_sub_f32 v55, v55, v4
  v_sub_f32 v56, v56, v4
  v_sub_f32 v57, v57, v4
  v_sub_f32 v58, v58, v4
  v_sub_f32 v59, v59, v4
  v_sub_f32 v60, v60, v4
  v_sub_f32 v61, v61, v4
  v_sub_f32 v62, v62, v4
  v_sub_f32 v63, v63, v4
  v_exp_f32 v48, v48
  v_exp_f32 v49, v49
  v_exp_f32 v50, v50
  v_exp_f32 v51, v51
  v_exp_f32 v52, v52
  v_exp_f32 v53, v53
  v_exp_f32 v54, v54
  v_exp_f32 v55, v55
  v_exp_f32 v56, v56
  v_exp_f32 v57, v57
  v_exp_f32 v58, v58
  v_exp_f32 v59, v59
  v_exp_f32 v60, v60
  v_exp_f32 v61, v61
  v_exp_f32 v62, v62
  v_exp_f32 v63, v63
  v_mul_f32 v80, v80, v97
  v_mul_f32 v81, v81, v97
  v_mul_f32 v82, v82, v97
  v_mul_f32 v83, v83, v97
  v_mul_f32 v84, v84, v97
  v_mul_f32 v85, v85, v97
  v_mul_f32 v86, v86, v97
  v_mul_f32 v87, v87, v97
  v_mul_f32 v88, v88, v97
  v_mul_f32 v89, v89, v97
  v_mul_f32 v90, v90, v97
  v_mul_f32 v91, v91, v97
  v_mul_f32 v92, v92, v97
  v_mul_f32 v93, v93, v97
  v_mul_f32 v94, v94, v97
  v_mul_f32 v95, v95, v97
  v_cvt_pk_bf16_f32 v36, v48, v49
  v_cvt_pk_bf16_f32 v37, v50, v51
  v_cvt_pk_bf16_f32 v38, v52, v53
  v_cvt_pk_bf16_f32 v39, v54, v55
  v_cvt_pk_bf16_f32 v40, v56, v57
  v_cvt_pk_bf16_f32 v41, v58, v59
  v_cvt_pk_bf16_f32 v42, v60, v61
  v_cvt_pk_bf16_f32 v43, v62, v63
  s_nop 1
  v_mfma_f32_32x32x16_bf16 v[80:95], v[20:23], v[36:39], v[80:95]
  v_mfma_f32_32x32x16_bf16 v[80:95], v[24:27], v[40:43], v[80:95]
  v_add_u32 v6, 1024, v6
  v_add_u32 v7, 1024, v7
  s_nop 7
  s_nop 7
  s_add_u32 s27, s27, 1
  s_cmp_lt_u32 s27, 64
  s_cbranch_scc1 B_FB
B_OK:
  v_rcp_f32 v4, v88
  v_sub_f32 v5, 1.0, v98
  v_mul_f32 v4, v4, v5
  v_mul_f32 v80, v80, v4
  v_mul_f32 v81, v81, v4
  v_mul_f32 v82, v82, v4
  v_mul_f32 v83, v83, v4
  v_mul_f32 v84, v84, v4
  v_mul_f32 v85, v85, v4
  v_mul_f32 v86, v86, v4
  v_mul_f32 v87, v87, v4
  v_cvt_pk_bf16_f32 v36, v80, v81
  v_cvt_pk_bf16_f32 v37, v82, v83
  v_cvt_pk_bf16_f32 v38, v84, v85
  v_cvt_pk_bf16_f32 v39, v86, v87
  s_mul_i32 s40, s25, 294912
  s_lshr_b32 s41, s26, 1
  s_add_u32 s41, s41, 128
  s_lshl_b32 s41, s41, 11
  s_add_u32 s40, s40, s41
  s_and_b32 s41, s26, 1
  s_lshl_b32 s41, s41, 9
  s_add_u32 s40, s40, s41
  s_add_u32 s40, s40, 67108864
  buffer_store_dwordx4 v[36:39], v3, s[8:11], s40 offen sc1
  s_lshl_b32 s40, s25, 5
  s_add_u32 s40, s40, s26
  s_lshl_b32 s40, s40, 2
  s_add_u32 s40, s40, 66125824
  v_mov_b32 v4, 1
  v_mov_b32 v5, 0
  s_waitcnt vmcnt(0)
  s_mov_b64 exec, 1
  buffer_store_dword v4, v5, s[8:11], s40 offen sc1
  s_mov_b64 exec, -1
  s_branch B_NEXT
B_DONE:
  s_waitcnt vmcnt(0)
  s_sub_u32 s24, s92, 1
  s_mov_b32 s25, 7
  s_mov_b32 s27, 0
  v_lshlrev_b32 v1, 4, v0
  v_bfe_u32 v10, v0, 3, 1
  v_lshlrev_b32 v2, 12, v10
  v_bfe_u32 v10, v0, 5, 1
  v_lshl_add_u32 v2, v10, 8, v2
  v_bfe_u32 v10, v0, 4, 1
  v_lshl_add_u32 v2, v10, 7, v2
  v_bfe_u32 v10, v0, 2, 1
  v_lshl_add_u32 v2, v10, 6, v2
  v_bfe_u32 v10, v0, 0, 2
  v_lshl_add_u32 v2, v10, 4, v2
  v_bfe_u32 v10, v0, 4, 1
  v_lshlrev_b32 v3, 10, v10
  v_bfe_u32 v10, v0, 5, 1
  v_lshl_add_u32 v3, v10, 8, v3
  v_bfe_u32 v10, v0, 0, 4
  v_lshl_add_u32 v3, v10, 4, v3
  v_bfe_u32 v10, v0, 4, 1
  v_lshlrev_b32 v4, 10, v10
  v_bfe_u32 v10, v0, 5, 1
  v_lshl_add_u32 v4, v10, 8, v4
  v_bfe_u32 v10, v0, 0, 4
  v_lshl_add_u32 v4, v10, 4, v4
  s_lshl_b32 s40, s21, 11
  v_bfe_u32 v10, v0, 5, 1
  v_lshlrev_b32 v5, 6, v10
  v_bfe_u32 v10, v0, 2, 2
  v_lshl_add_u32 v5, v10, 4, v5
  v_bfe_u32 v10, v0, 0, 1
  v_lshl_add_u32 v5, v10, 3, v5
  v_add_u32 v5, s40, v5
  s_lshl_b32 s40, s21, 9
  v_bfe_u32 v10, v0, 0, 5
  v_lshlrev_b32 v6, 4, v10
  v_bfe_u32 v10, v0, 5, 1
  v_lshl_add_u32 v6, v10, 3, v6
  v_add_u32 v6, s40, v6
  v_and_b32 v7, 31, v0
  v_lshrrev_b32 v10, 5, v0
  v_lshlrev_b32 v10, 2, v10
  v_sub_u32 v7, v7, v10
  s_lshl_b32 s40, s20, 5
  v_bfe_u32 v10, v0, 4, 2
  v_lshlrev_b32 v8, 12, v10
  v_bfe_u32 v10, v0, 0, 4
  v_lshl_add_u32 v8, v10, 1, v8
  v_add_u32 v8, s40, v8
  s_mov_b32 s12, s86
  s_and_b32 s13, s87, 0xffff
  s_mov_b32 s14, 0x200000
  s_mov_b32 s15, 0x20000
  s_lshl_b32 s40, s21, 13
  s_add_u32 s40, s40, 16384
  v_add_u32 v201, s40, v1
  v_bfe_u32 v10, v0, 5, 1
  v_lshlrev_b32 v202, 9, v10
  v_bfe_u32 v10, v0, 4, 1
  v_lshl_add_u32 v202, v10, 7, v202
  v_bfe_u32 v10, v0, 2, 2
  v_lshl_add_u32 v202, v10, 5, v202
  v_bfe_u32 v10, v0, 0, 2
  v_lshl_add_u32 v202, v10, 3, v202
  v_add_u32 v202, s40, v202
  s_waitcnt vmcnt(0)
  ds_write_b128 v201, a[0:3] offset:0
  ds_write_b128 v201, a[4:7] offset:1024
  ds_write_b128 v201, a[8:11] offset:2048
  ds_write_b128 v201, a[12:15] offset:3072
  ds_write_b128 v201, a[16:19] offset:4096
  ds_write_b128 v201, a[20:23] offset:5120
  ds_write_b128 v201, a[24:27] offset:6144
  ds_write_b128 v201, a[28:31] offset:7168
  s_waitcnt lgkmcnt(0)
  ds_read_b64_tr_b16 a[0:1], v202 offset:0
  ds_read_b64_tr_b16 a[2:3], v202 offset:256
  ds_read_b64_tr_b16 a[4:5], v202 offset:1024
  ds_read_b64_tr_b16 a[6:7], v202 offset:1280
  ds_read_b64_tr_b16 a[8:9], v202 offset:2048
  ds_read_b64_tr_b16 a[10:11], v202 offset:2304
  ds_read_b64_tr_b16 a[12:13], v202 offset:3072
  ds_read_b64_tr_b16 a[14:15], v202 offset:3328
  ds_read_b64_tr_b16 a[16:17], v202 offset:4096
  ds_read_b64_tr_b16 a[18:19], v202 offset:4352
  ds_read_b64_tr_b16 a[20:21], v202 offset:5120
  ds_read_b64_tr_b16 a[22:23], v202 offset:5376
  ds_read_b64_tr_b16 a[24:25], v202 offset:6144
  ds_read_b64_tr_b16 a[26:27], v202 offset:6400
  ds_read_b64_tr_b16 a[28:29], v202 offset:7168
  ds_read_b64_tr_b16 a[30:31], v202 offset:7424
  s_waitcnt lgkmcnt(0)
  ds_write_b128 v201, a[32:35] offset:0
  ds_write_b128 v201, a[36:39] offset:1024
  ds_write_b128 v201, a[40:43] offset:2048
  ds_write_b128 v201, a[44:47] offset:3072
  ds_write_b128 v201, a[48:51] offset:4096
  ds_write_b128 v201, a[52:55] offset:5120
  ds_write_b128 v201, a[56:59] offset:6144
  ds_write_b128 v201, a[60:63] offset:7168
  s_waitcnt lgkmcnt(0)
  ds_read_b64_tr_b16 a[32:33], v202 offset:0
  ds_read_b64_tr_b16 a[34:35], v202 offset:256
  ds_read_b64_tr_b16 a[36:37], v202 offset:1024
  ds_read_b64_tr_b16 a[38:39], v202 offset:1280
  ds_read_b64_tr_b16 a[40:41], v202 offset:2048
  ds_read_b64_tr_b16 a[42:43], v202 offset:2304
  ds_read_b64_tr_b16 a[44:45], v202 offset:3072
  ds_read_b64_tr_b16 a[46:47], v202 offset:3328
  ds_read_b64_tr_b16 a[48:49], v202 offset:4096
  ds_read_b64_tr_b16 a[50:51], v202 offset:4352
  ds_read_b64_tr_b16 a[52:53], v202 offset:5120
  ds_read_b64_tr_b16 a[54:55], v202 offset:5376
  ds_read_b64_tr_b16 a[56:57], v202 offset:6144
  ds_read_b64_tr_b16 a[58:59], v202 offset:6400
  ds_read_b64_tr_b16 a[60:61], v202 offset:7168
  ds_read_b64_tr_b16 a[62:63], v202 offset:7424
  s_waitcnt lgkmcnt(0)
  ds_write_b128 v201, a[64:67] offset:0
  ds_write_b128 v201, a[68:71] offset:1024
  ds_write_b128 v201, a[72:75] offset:2048
  ds_write_b128 v201, a[76:79] offset:3072
  ds_write_b128 v201, a[80:83] offset:4096
  ds_write_b128 v201, a[84:87] offset:5120
  ds_write_b128 v201, a[88:91] offset:6144
  ds_write_b128 v201, a[92:95] offset:7168
  s_waitcnt lgkmcnt(0)
  ds_read_b64_tr_b16 a[64:65], v202 offset:0
  ds_read_b64_tr_b16 a[66:67], v202 offset:256
  ds_read_b64_tr_b16 a[68:69], v202 offset:1024
  ds_read_b64_tr_b16 a[70:71], v202 offset:1280
  ds_read_b64_tr_b16 a[72:73], v202 offset:2048
  ds_read_b64_tr_b16 a[74:75], v202 offset:2304
  ds_read_b64_tr_b16 a[76:77], v202 offset:3072
  ds_read_b64_tr_b16 a[78:79], v202 offset:3328
  ds_read_b64_tr_b16 a[80:81], v202 offset:4096
  ds_read_b64_tr_b16 a[82:83], v202 offset:4352
  ds_read_b64_tr_b16 a[84:85], v202 offset:5120
  ds_read_b64_tr_b16 a[86:87], v202 offset:5376
  ds_read_b64_tr_b16 a[88:89], v202 offset:6144
  ds_read_b64_tr_b16 a[90:91], v202 offset:6400
  ds_read_b64_tr_b16 a[92:93], v202 offset:7168
  ds_read_b64_tr_b16 a[94:95], v202 offset:7424
  s_waitcnt lgkmcnt(0)
  ds_write_b128 v201, a[96:99] offset:0
  ds_write_b128 v201, a[100:103] offset:1024
  ds_write_b128 v201, a[104:107] offset:2048
  ds_write_b128 v201, a[108:111] offset:3072
  ds_write_b128 v201, a[112:115] offset:4096
  ds_write_b128 v201, a[116:119] offset:5120
  ds_write_b128 v201, a[120:123] offset:6144
  ds_write_b128 v201, a[124:127] offset:7168
  s_waitcnt lgkmcnt(0)
  ds_read_b64_tr_b16 a[96:97], v202 offset:0
  ds_read_b64_tr_b16 a[98:99], v202 offset:256
  ds_read_b64_tr_b16 a[100:101], v202 offset:1024
  ds_read_b64_tr_b16 a[102:103], v202 offset:1280
  ds_read_b64_tr_b16 a[104:105], v202 offset:2048
  ds_read_b64_tr_b16 a[106:107], v202 offset:2304
  ds_read_b64_tr_b16 a[108:109], v202 offset:3072
  ds_read_b64_tr_b16 a[110:111], v202 offset:3328
  ds_read_b64_tr_b16 a[112:113], v202 offset:4096
  ds_read_b64_tr_b16 a[114:115], v202 offset:4352
  ds_read_b64_tr_b16 a[116:117], v202 offset:5120
  ds_read_b64_tr_b16 a[118:119], v202 offset:5376
  ds_read_b64_tr_b16 a[120:121], v202 offset:6144
  ds_read_b64_tr_b16 a[122:123], v202 offset:6400
  ds_read_b64_tr_b16 a[124:125], v202 offset:7168
  ds_read_b64_tr_b16 a[126:127], v202 offset:7424
  s_waitcnt lgkmcnt(0)
  ds_write_b128 v201, a[128:131] offset:0
  ds_write_b128 v201, a[132:135] offset:1024
  ds_write_b128 v201, a[136:139] offset:2048
  ds_write_b128 v201, a[140:143] offset:3072
  s_waitcnt lgkmcnt(0)
  ds_read_b64_tr_b16 a[128:129], v202 offset:0
  ds_read_b64_tr_b16 a[130:131], v202 offset:256
  ds_read_b64_tr_b16 a[132:133], v202 offset:1024
  ds_read_b64_tr_b16 a[134:135], v202 offset:1280
  ds_read_b64_tr_b16 a[136:137], v202 offset:2048
  ds_read_b64_tr_b16 a[138:139], v202 offset:2304
  ds_read_b64_tr_b16 a[140:141], v202 offset:3072
  ds_read_b64_tr_b16 a[142:143], v202 offset:3328
  s_waitcnt lgkmcnt(0)
  v_min_u32 v10, 2, v0
  v_lshlrev_b32 v13, 13, v10
  s_lshl_b32 s40, s20, 8
  v_add_u32 v13, s40, v13
  v_bfe_u32 v10, v0, 0, 5
  v_lshlrev_b32 v14, 2, v10
  v_lshrrev_b32 v10, 5, v0
  v_xor_b32 v10, 1, v10
  v_lshl_add_u32 v14, v10, 13, v14
  v_mov_b32 v9, 0
  s_and_b32 s40, s24, 1
  s_lshl_b32 s40, s40, 7
  s_add_u32 s40, s40, 66060288
  s_lshr_b32 s41, s24, 1
  s_add_u32 s41, s41, 1
  s_mov_b32 s28, 0
FP0_P:
  buffer_load_dword v10, v13, s[8:11], s40 offen sc1
  s_add_u32 s28, s28, 1
  s_cmp_gt_u32 s28, 4000000
  s_cbranch_scc1 K_ABORT
  s_waitcnt vmcnt(0)
  v_cmp_gt_u32 vcc, s41, v10
  s_cbranch_vccz FP0_PD
  s_sleep 4
  s_branch FP0_P
FP0_PD:
  s_lshl_b32 s40, s24, 5
  s_add_u32 s40, s40, s20
  s_lshl_b32 s40, s40, 13
  s_add_u32 s41, s40, 33554432
  s_add_u32 s42, s40, 0
  s_add_u32 s44, s40, 16777216
  s_lshl_b32 s45, s21, 11
  s_add_u32 s44, s44, s45
  buffer_load_dwordx4 a[144:147], v2, s[8:11], s41 offen offset:0
  buffer_load_dwordx4 a[148:151], v2, s[8:11], s41 offen offset:512
  buffer_load_dwordx4 a[152:155], v2, s[8:11], s41 offen offset:1024
  buffer_load_dwordx4 a[156:159], v2, s[8:11], s41 offen offset:1536
  buffer_load_dwordx4 a[160:163], v2, s[8:11], s41 offen offset:2048
  buffer_load_dwordx4 a[164:167], v2, s[8:11], s41 offen offset:2560
  buffer_load_dwordx4 a[168:171], v2, s[8:11], s41 offen offset:3072
  buffer_load_dwordx4 a[172:175], v2, s[8:11], s41 offen offset:3584
  buffer_load_dwordx4 a[176:179], v2, s[8:11], s42 offen offset:0
  buffer_load_dwordx4 a[180:183], v2, s[8:11], s42 offen offset:512
  buffer_load_dwordx4 a[184:187], v2, s[8:11], s42 offen offset:1024
  buffer_load_dwordx4 a[188:191], v2, s[8:11], s42 offen offset:1536
  buffer_load_dwordx4 a[192:195], v2, s[8:11], s42 offen offset:2048
  buffer_load_dwordx4 a[196:199], v2, s[8:11], s42 offen offset:2560
  buffer_load_dwordx4 a[200:203], v2, s[8:11], s42 offen offset:3072
  buffer_load_dwordx4 a[204:207], v2, s[8:11], s42 offen offset:3584
  buffer_load_dwordx4 a[208:211], v3, s[8:11], s44 offen offset:0
  buffer_load_dwordx4 a[212:215], v3, s[8:11], s44 offen offset:512
  s_lshl_b32 s40, s24, 7
  s_add_u32 s40, s40, 65142784
  v_and_b32 v10, 31, v0
  v_lshlrev_b32 v10, 2, v10
  buffer_load_dword v12, v10, s[8:11], s40 offen sc1
F_LOOP:
  s_lshl_b32 s40, s20, 7
  s_add_u32 s40, s40, 66093056
  s_add_u32 s41, s24, 1
  s_mov_b32 s28, 0
FWM_P:
  buffer_load_dword v10, v9, s[8:11], s40 offen sc1
  s_add_u32 s28, s28, 1
  s_cmp_gt_u32 s28, 4000000
  s_cbranch_scc1 K_ABORT
  s_waitcnt vmcnt(0)
  v_cmp_gt_u32 vcc, s41, v10
  s_cbranch_vccz FWM_PD
  s_sleep 1
  s_branch FWM_P
FWM_PD:
  s_lshl_b32 s40, s24, 5
  s_add_u32 s40, s40, s20
  s_lshl_b32 s41, s40, 11
  s_add_u32 s42, s41, 50331648
  s_add_u32 s43, s41, 54525952
  s_lshl_b32 s44, s21, 11
  s_mov_b32 m0, s44
  s_add_u32 s44, s44, 1024
  buffer_load_dwordx4 v1, s[8:11], s42 offen sc1 lds
  s_mov_b32 m0, s44
  s_add_u32 s42, s42, 1024
  buffer_load_dwordx4 v1, s[8:11], s42 offen sc1 lds
  buffer_load_dwordx2 v[120:121], v6, s[8:11], s43 offen sc1
  v_mov_b64 v[122:123], 0
  v_mov_b64 v[170:171], 0
  s_waitcnt vmcnt(3)
  v_mfma_f32_32x32x16_bf16 v[128:143], a[176:179], a[144:147], 0
  v_mfma_f32_32x32x16_bf16 v[128:143], a[180:183], a[148:151], v[128:143]
  v_mfma_f32_32x32x16_bf16 v[128:143], a[184:187], a[152:155], v[128:143]
  v_mfma_f32_32x32x16_bf16 v[128:143], a[188:191], a[156:159], v[128:143]
  v_mfma_f32_32x32x16_bf16 v[128:143], a[192:195], a[160:163], v[128:143]
  v_mfma_f32_32x32x16_bf16 v[128:143], a[196:199], a[164:167], v[128:143]
  v_mfma_f32_32x32x16_bf16 v[128:143], a[200:203], a[168:171], v[128:143]
  v_mfma_f32_32x32x16_bf16 v[128:143], a[204:207], a[172:175], v[128:143]
  s_waitcnt vmcnt(1)
  ds_read_b64_tr_b16 v[80:81], v5 offset:0
  ds_read_b64_tr_b16 v[82:83], v5 offset:128
  ds_read_b64_tr_b16 v[84:85], v5 offset:256
  ds_read_b64_tr_b16 v[86:87], v5 offset:384
  ds_read_b64_tr_b16 v[88:89], v5 offset:512
  ds_read_b64_tr_b16 v[90:91], v5 offset:640
  ds_read_b64_tr_b16 v[92:93], v5 offset:768
  ds_read_b64_tr_b16 v[94:95], v5 offset:896
  ds_read_b64_tr_b16 v[96:97], v5 offset:1024
  ds_read_b64_tr_b16 v[98:99], v5 offset:1152
  ds_read_b64_tr_b16 v[100:101], v5 offset:1280
  ds_read_b64_tr_b16 v[102:103], v5 offset:1408
  ds_read_b64_tr_b16 v[104:105], v5 offset:1536
  ds_read_b64_tr_b16 v[106:107], v5 offset:1664
  ds_read_b64_tr_b16 v[108:109], v5 offset:1792
  ds_read_b64_tr_b16 v[110:111], v5 offset:1920
  v_mov_b32 v11, 0xd0284a9a
  s_nop 7
  v_cmp_gt_i32 vcc, 0, v7
  s_nop 1
  v_cndmask_b32 v128, v128, v11, vcc
  v_cmp_gt_i32 vcc, 1, v7
  s_nop 1
  v_cndmask_b32 v129, v129, v11, vcc
  v_cmp_gt_i32 vcc, 2, v7
  s_nop 1
  v_cndmask_b32 v130, v130, v11, vcc
  v_cmp_gt_i32 vcc, 3, v7
  s_nop 1
  v_cndmask_b32 v131, v131, v11, vcc
  v_cmp_gt_i32 vcc, 8, v7
  s_nop 1
  v_cndmask_b32 v132, v132, v11, vcc
  v_cmp_gt_i32 vcc, 9, v7
  s_nop 1
  v_cndmask_b32 v133, v133, v11, vcc
  v_cmp_gt_i32 vcc, 10, v7
  s_nop 1
  v_cndmask_b32 v134, v134, v11, vcc
  v_cmp_gt_i32 vcc, 11, v7
  s_nop 1
  v_cndmask_b32 v135, v135, v11, vcc
  v_cmp_gt_i32 vcc, 16, v7
  s_nop 1
  v_cndmask_b32 v136, v136, v11, vcc
  v_cmp_gt_i32 vcc, 17, v7
  s_nop 1
  v_cndmask_b32 v137, v137, v11, vcc
  v_cmp_gt_i32 vcc, 18, v7
  s_nop 1
  v_cndmask_b32 v138, v138, v11, vcc
  v_cmp_gt_i32 vcc, 19, v7
  s_nop 1
  v_cndmask_b32 v139, v139, v11, vcc
  v_cmp_gt_i32 vcc, 24, v7
  s_nop 1
  v_cndmask_b32 v140, v140, v11, vcc
  v_cmp_gt_i32 vcc, 25, v7
  s_nop 1
  v_cndmask_b32 v141, v141, v11, vcc
  v_cmp_gt_i32 vcc, 26, v7
  s_nop 1
  v_cndmask_b32 v142, v142, v11, vcc
  v_cmp_gt_i32 vcc, 27, v7
  s_nop 1
  v_cndmask_b32 v143, v143, v11, vcc
  s_waitcnt lgkmcnt(0)
  v_mfma_f32_32x32x16_bf16 v[144:159], v[80:83], a[144:147], 0
  v_mfma_f32_32x32x16_bf16 v[144:159], v[84:87], a[148:151], v[144:159]
  v_mfma_f32_32x32x16_bf16 v[144:159], v[88:91], a[152:155], v[144:159]
  v_mfma_f32_32x32x16_bf16 v[144:159], v[92:95], a[156:159], v[144:159]
  v_mfma_f32_32x32x16_bf16 v[144:159], v[96:99], a[160:163], v[144:159]
  v_mfma_f32_32x32x16_bf16 v[144:159], v[100:103], a[164:167], v[144:159]
  v_mfma_f32_32x32x16_bf16 v[144:159], v[104:107], a[168:171], v[144:159]
  v_mfma_f32_32x32x16_bf16 v[144:159], v[108:111], a[172:175], v[144:159]
  s_nop 7
  s_nop 3
  v_max3_f32 v10, v144, v145, v146
  v_max3_f32 v10, v10, v147, v128
  v_max3_f32 v10, v10, v129, v130
  v_max3_f32 v10, v10, v131, v132
  v_max3_f32 v10, v10, v133, v134
  v_max3_f32 v10, v10, v135, v136
  v_max3_f32 v10, v10, v137, v138
  v_max3_f32 v10, v10, v139, v140
  v_max3_f32 v10, v10, v141, v142
  v_max_f32 v10, v10, v143
  v_mov_b32 v11, v10
  s_nop 1
  v_permlane32_swap_b32 v10, v11
  s_nop 0
  v_max_f32 v10, v10, v11
  s_mov_b32 s40, 0x3e0293ee
  v_sub_f32 v128, v128, v10
  v_sub_f32 v129, v129, v10
  v_sub_f32 v130, v130, v10
  v_sub_f32 v131, v131, v10
  v_sub_f32 v132, v132, v10
  v_sub_f32 v133, v133, v10
  v_sub_f32 v134, v134, v10
  v_sub_f32 v135, v135, v10
  v_sub_f32 v136, v136, v10
  v_sub_f32 v137, v137, v10
  v_sub_f32 v138, v138, v10
  v_sub_f32 v139, v139, v10
  v_sub_f32 v140, v140, v10
  v_sub_f32 v141, v141, v10
  v_sub_f32 v142, v142, v10
  v_sub_f32 v143, v143, v10
  v_sub_f32 v144, v144, v10
  v_sub_f32 v145, v145, v10
  v_sub_f32 v146, v146, v10
  v_sub_f32 v147, v147, v10
  v_mul_f32 v128, s40, v128
  v_mul_f32 v129, s40, v129
  v_mul_f32 v130, s40, v130
  v_mul_f32 v131, s40, v131
  v_mul_f32 v132, s40, v132
  v_mul_f32 v133, s40, v133
  v_mul_f32 v134, s40, v134
  v_mul_f32 v135, s40, v135
  v_mul_f32 v136, s40, v136
  v_mul_f32 v137, s40, v137
  v_mul_f32 v138, s40, v138
  v_mul_f32 v139, s40, v139
  v_mul_f32 v140, s40, v140
  v_mul_f32 v141, s40, v141
  v_mul_f32 v142, s40, v142
  v_mul_f32 v143, s40, v143
  v_mul_f32 v144, s40, v144
  v_mul_f32 v145, s40, v145
  v_mul_f32 v146, s40, v146
  v_mul_f32 v147, s40, v147
  v_exp_f32 v128, v128
  v_exp_f32 v129, v129
  v_exp_f32 v130, v130
  v_exp_f32 v131, v131
  v_exp_f32 v132, v132
  v_exp_f32 v133, v133
  v_exp_f32 v134, v134
  v_exp_f32 v135, v135
  v_exp_f32 v136, v136
  v_exp_f32 v137, v137
  v_exp_f32 v138, v138
  v_exp_f32 v139, v139
  v_exp_f32 v140, v140
  v_exp_f32 v141, v141
  v_exp_f32 v142, v142
  v_exp_f32 v143, v143
  v_exp_f32 v144, v144
  v_exp_f32 v145, v145
  v_exp_f32 v146, v146
  v_exp_f32 v147, v147
  s_nop 0
  v_cvt_pk_bf16_f32 v160, v128, v129
  v_cvt_pk_bf16_f32 v161, v130, v131
  v_cvt_pk_bf16_f32 v162, v132, v133
  v_cvt_pk_bf16_f32 v163, v134, v135
  v_cvt_pk_bf16_f32 v164, v136, v137
  v_cvt_pk_bf16_f32 v165, v138, v139
  v_cvt_pk_bf16_f32 v166, v140, v141
  v_cvt_pk_bf16_f32 v167, v142, v143
  v_cvt_pk_bf16_f32 v168, v144, v145
  v_cvt_pk_bf16_f32 v169, v146, v147
  s_waitcnt vmcnt(0)
  v_mfma_f32_32x32x16_bf16 v[176:191], a[208:211], v[160:163], 0
  v_mfma_f32_32x32x16_bf16 v[176:191], a[212:215], v[164:167], v[176:191]
  v_mfma_f32_32x32x16_bf16 v[176:191], v[120:123], v[168:171], v[176:191]
  v_add_f32 v10, v144, v145
  v_add_f32 v11, v146, v147
  v_add_f32 v10, v10, v128
  v_add_f32 v11, v11, v129
  v_add_f32 v10, v10, v130
  v_add_f32 v11, v11, v131
  v_add_f32 v10, v10, v132
  v_add_f32 v11, v11, v133
  v_add_f32 v10, v10, v134
  v_add_f32 v11, v11, v135
  v_add_f32 v10, v10, v136
  v_add_f32 v11, v11, v137
  v_add_f32 v10, v10, v138
  v_add_f32 v11, v11, v139
  v_add_f32 v10, v10, v140
  v_add_f32 v11, v11, v141
  v_add_f32 v10, v10, v142
  v_add_f32 v11, v11, v143
  v_add_f32 v10, v10, v11
  v_mov_b32 v11, v10
  s_nop 1
  v_permlane32_swap_b32 v10, v11
  s_nop 0
  v_add_f32 v10, v10, v11
  v_rcp_f32 v10, v10
  s_nop 0
  v_mul_f32 v10, v10, v12
  s_nop 3
  v_mul_f32 v176, v176, v10
  v_mul_f32 v177, v177, v10
  v_mul_f32 v178, v178, v10
  v_mul_f32 v179, v179, v10
  v_mul_f32 v180, v180, v10
  v_mul_f32 v181, v181, v10
  v_mul_f32 v182, v182, v10
  v_mul_f32 v183, v183, v10
  v_mul_f32 v184, v184, v10
  v_mul_f32 v185, v185, v10
  v_mul_f32 v186, v186, v10
  v_mul_f32 v187, v187, v10
  v_mul_f32 v188, v188, v10
  v_mul_f32 v189, v189, v10
  v_mul_f32 v190, v190, v10
  v_mul_f32 v191, v191, v10
  v_cvt_pk_bf16_f32 v160, v176, v177
  v_cvt_pk_bf16_f32 v161, v178, v179
  v_cvt_pk_bf16_f32 v162, v180, v181
  v_cvt_pk_bf16_f32 v163, v182, v183
  v_cvt_pk_bf16_f32 v164, v184, v185
  v_cvt_pk_bf16_f32 v165, v186, v187
  v_cvt_pk_bf16_f32 v166, v188, v189
  v_cvt_pk_bf16_f32 v167, v190, v191
  s_mul_i32 s40, s24, 294912
  s_add_u32 s46, s40, 67108864
  s_lshl_b32 s41, s20, 2
  s_add_u32 s41, s41, s21
  s_lshl_b32 s41, s41, 11
  s_add_u32 s40, s46, s41
  buffer_store_dwordx4 v[160:163], v4, s[8:11], s40 offen
  buffer_store_dwordx4 v[164:167], v4, s[8:11], s40 offen offset:512
  s_waitcnt vmcnt(0)
  s_barrier
  s_lshl_b32 s40, s24, 7
  s_add_u32 s45, s40, 66134016
  s_cmp_eq_u32 s21, 0
  s_cbranch_scc0 F_NOFL
  s_lshl_b32 s41, s20, 2
  v_mov_b32 v10, 1
  v_mov_b32 v11, s41
  s_mov_b64 exec, 1
  buffer_store_dword v10, v11, s[8:11], s45 offen
  s_mov_b64 exec, -1
F_NOFL:
  s_add_u32 s26, s24, s25
  s_cmp_ge_u32 s26, 64
  s_cbranch_scc1 F_NOPF
  s_and_b32 s40, s26, 1
  s_lshl_b32 s40, s40, 7
  s_add_u32 s40, s40, 66060288
  s_lshr_b32 s41, s26, 1
  s_add_u32 s41, s41, 1
  s_mov_b32 s28, 0
FP1_P:
  buffer_load_dword v10, v13, s[8:11], s40 offen sc1
  s_add_u32 s28, s28, 1
  s_cmp_gt_u32 s28, 4000000
  s_cbranch_scc1 K_ABORT
  s_waitcnt vmcnt(0)
  v_cmp_gt_u32 vcc, s41, v10
  s_cbranch_vccz FP1_PD
  s_sleep 4
  s_branch FP1_P
FP1_PD:
  s_lshl_b32 s40, s26, 5
  s_add_u32 s40, s40, s20
  s_lshl_b32 s40, s40, 13
  s_add_u32 s41, s40, 33554432
  s_add_u32 s42, s40, 0
  s_add_u32 s44, s40, 16777216
  s_lshl_b32 s45, s21, 11
  s_add_u32 s44, s44, s45
  buffer_load_dwordx4 a[144:147], v2, s[8:11], s41 offen offset:0
  buffer_load_dwordx4 a[148:151], v2, s[8:11], s41 offen offset:512
  buffer_load_dwordx4 a[152:155], v2, s[8:11], s41 offen offset:1024
  buffer_load_dwordx4 a[156:159], v2, s[8:11], s41 offen offset:1536
  buffer_load_dwordx4 a[160:163], v2, s[8:11], s41 offen offset:2048
  buffer_load_dwordx4 a[164:167], v2, s[8:11], s41 offen offset:2560
  buffer_load_dwordx4 a[168:171], v2, s[8:11], s41 offen offset:3072
  buffer_load_dwordx4 a[172:175], v2, s[8:11], s41 offen offset:3584
  buffer_load_dwordx4 a[176:179], v2, s[8:11], s42 offen offset:0
  buffer_load_dwordx4 a[180:183], v2, s[8:11], s42 offen offset:512
  buffer_load_dwordx4 a[184:187], v2, s[8:11], s42 offen offset:1024
  buffer_load_dwordx4 a[188:191], v2, s[8:11], s42 offen offset:1536
  buffer_load_dwordx4 a[192:195], v2, s[8:11], s42 offen offset:2048
  buffer_load_dwordx4 a[196:199], v2, s[8:11], s42 offen offset:2560
  buffer_load_dwordx4 a[200:203], v2, s[8:11], s42 offen offset:3072
  buffer_load_dwordx4 a[204:207], v2, s[8:11], s42 offen offset:3584
  buffer_load_dwordx4 a[208:211], v3, s[8:11], s44 offen offset:0
  buffer_load_dwordx4 a[212:215], v3, s[8:11], s44 offen offset:512
  s_lshl_b32 s40, s26, 7
  s_add_u32 s40, s40, 65142784
  v_and_b32 v10, 31, v0
  v_lshlrev_b32 v10, 2, v10
  buffer_load_dword v12, v10, s[8:11], s40 offen sc1
F_NOPF:
  s_lshl_b32 s40, s24, 7
  s_add_u32 s40, s40, 66125824
  s_mov_b32 s28, 0
FA_P:
  buffer_load_dword v10, v14, s[8:11], s40 offen sc1
  s_add_u32 s28, s28, 1
  s_cmp_gt_u32 s28, 4000000
  s_cbranch_scc1 K_ABORT
  s_waitcnt vmcnt(0)
  v_cmp_eq_u32 vcc, 0, v10
  s_cbranch_vccz FA_PD
  s_sleep 1
  s_branch FA_P
FA_PD:
  s_lshl_b32 s40, s21, 16
  s_add_u32 s40, s40, s46
  s_lshl_b32 s41, s21, 13
  s_add_u32 s41, s41, s46
  s_add_u32 s41, s41, 262144
  s_lshl_b32 s42, s20, 11
  s_add_u32 s43, s40, s42
  buffer_load_dwordx4 v[16:19], v1, s[8:11], s43 offen sc1
  buffer_load_dwordx4 v[20:23], v1, s[8:11], s43 offen offset:1024 sc1
  s_add_u32 s42, s42, 2048
  s_and_b32 s42, s42, 0xffff
  s_add_u32 s43, s40, s42
  buffer_load_dwordx4 v[24:27], v1, s[8:11], s43 offen sc1
  buffer_load_dwordx4 v[28:31], v1, s[8:11], s43 offen offset:1024 sc1
  s_add_u32 s42, s42, 2048
  s_and_b32 s42, s42, 0xffff
  s_add_u32 s43, s40, s42
  buffer_load_dwordx4 v[32:35], v1, s[8:11], s43 offen sc1
  buffer_load_dwordx4 v[36:39], v1, s[8:11], s43 offen offset:1024 sc1
  s_add_u32 s42, s42, 2048
  s_and_b32 s42, s42, 0xffff
  s_add_u32 s43, s40, s42
  buffer_load_dwordx4 v[40:43], v1, s[8:11], s43 offen sc1
  buffer_load_dwordx4 v[44:47], v1, s[8:11], s43 offen offset:1024 sc1
  s_add_u32 s42, s42, 2048
  s_and_b32 s42, s42, 0xffff
  s_add_u32 s43, s40, s42
  buffer_load_dwordx4 v[48:51], v1, s[8:11], s43 offen sc1
  buffer_load_dwordx4 v[52:55], v1, s[8:11], s43 offen offset:1024 sc1
  s_add_u32 s42, s42, 2048
  s_and_b32 s42, s42, 0xffff
  s_add_u32 s43, s40, s42
  buffer_load_dwordx4 v[56:59], v1, s[8:11], s43 offen sc1
  buffer_load_dwordx4 v[60:63], v1, s[8:11], s43 offen offset:1024 sc1
  s_add_u32 s42, s42, 2048
  s_and_b32 s42, s42, 0xffff
  s_add_u32 s43, s40, s42
  buffer_load_dwordx4 v[64:67], v1, s[8:11], s43 offen sc1
  buffer_load_dwordx4 v[68:71], v1, s[8:11], s43 offen offset:1024 sc1
  s_add_u32 s42, s42, 2048
  s_and_b32 s42, s42, 0xffff
  s_add_u32 s43, s40, s42
  buffer_load_dwordx4 v[72:75], v1, s[8:11], s43 offen sc1
  buffer_load_dwordx4 v[76:79], v1, s[8:11], s43 offen offset:1024 sc1
  s_add_u32 s42, s42, 2048
  s_and_b32 s42, s42, 0xffff
  s_add_u32 s43, s40, s42
  buffer_load_dwordx4 v[80:83], v1, s[8:11], s43 offen sc1
  buffer_load_dwordx4 v[84:87], v1, s[8:11], s43 offen offset:1024 sc1
  s_add_u32 s42, s42, 2048
  s_and_b32 s42, s42, 0xffff
  s_add_u32 s43, s40, s42
  buffer_load_dwordx4 v[88:91], v1, s[8:11], s43 offen sc1
  buffer_load_dwordx4 v[92:95], v1, s[8:11], s43 offen offset:1024 sc1
  s_add_u32 s42, s42, 2048
  s_and_b32 s42, s42, 0xffff
  s_add_u32 s43, s40, s42
  buffer_load_dwordx4 v[96:99], v1, s[8:11], s43 offen sc1
  buffer_load_dwordx4 v[100:103], v1, s[8:11], s43 offen offset:1024 sc1
  s_add_u32 s42, s42, 2048
  s_and_b32 s42, s42, 0xffff
  s_add_u32 s43, s40, s42
  buffer_load_dwordx4 v[104:107], v1, s[8:11], s43 offen sc1
  buffer_load_dwordx4 v[108:111], v1, s[8:11], s43 offen offset:1024 sc1
  s_add_u32 s42, s42, 2048
  s_and_b32 s42, s42, 0xffff
  s_add_u32 s43, s40, s42
  buffer_load_dwordx4 v[112:115], v1, s[8:11], s43 offen sc1
  buffer_load_dwordx4 v[116:119], v1, s[8:11], s43 offen offset:1024 sc1
  s_add_u32 s42, s42, 2048
  s_and_b32 s42, s42, 0xffff
  s_add_u32 s43, s40, s42
  buffer_load_dwordx4 v[120:123], v1, s[8:11], s43 offen sc1
  buffer_load_dwordx4 v[124:127], v1, s[8:11], s43 offen offset:1024 sc1
  s_add_u32 s42, s42, 2048
  s_and_b32 s42, s42, 0xffff
  s_add_u32 s43, s40, s42
  buffer_load_dwordx4 v[128:131], v1, s[8:11], s43 offen sc1
  buffer_load_dwordx4 v[132:135], v1, s[8:11], s43 offen offset:1024 sc1
  s_add_u32 s42, s42, 2048
  s_and_b32 s42, s42, 0xffff
  s_add_u32 s43, s40, s42
  buffer_load_dwordx4 v[136:139], v1, s[8:11], s43 offen sc1
  buffer_load_dwordx4 v[140:143], v1, s[8:11], s43 offen offset:1024 sc1
  s_add_u32 s42, s42, 2048
  s_and_b32 s42, s42, 0xffff
  s_waitcnt vmcnt(30)
  v_mfma_f32_16x16x32_bf16 v[192:195], v[16:19], a[0:3], 0
  v_mfma_f32_16x16x32_bf16 v[196:199], v[20:23], a[0:3], 0
  s_add_u32 s43, s40, s42
  buffer_load_dwordx4 v[16:19], v1, s[8:11], s43 offen sc1
  buffer_load_dwordx4 v[20:23], v1, s[8:11], s43 offen offset:1024 sc1
  s_add_u32 s42, s42, 2048
  s_and_b32 s42, s42, 0xffff
  s_waitcnt vmcnt(30)
  v_mfma_f32_16x16x32_bf16 v[192:195], v[24:27], a[4:7], v[192:195]
  v_mfma_f32_16x16x32_bf16 v[196:199], v[28:31], a[4:7], v[196:199]
  s_add_u32 s43, s40, s42
  buffer_load_dwordx4 v[24:27], v1, s[8:11], s43 offen sc1
  buffer_load_dwordx4 v[28:31], v1, s[8:11], s43 offen offset:1024 sc1
  s_add_u32 s42, s42, 2048
  s_and_b32 s42, s42, 0xffff
  s_waitcnt vmcnt(30)
  v_mfma_f32_16x16x32_bf16 v[192:195], v[32:35], a[8:11], v[192:195]
  v_mfma_f32_16x16x32_bf16 v[196:199], v[36:39], a[8:11], v[196:199]
  s_add_u32 s43, s40, s42
  buffer_load_dwordx4 v[32:35], v1, s[8:11], s43 offen sc1
  buffer_load_dwordx4 v[36:39], v1, s[8:11], s43 offen offset:1024 sc1
  s_add_u32 s42, s42, 2048
  s_and_b32 s42, s42, 0xffff
  s_waitcnt vmcnt(30)
  v_mfma_f32_16x16x32_bf16 v[192:195], v[40:43], a[12:15], v[192:195]
  v_mfma_f32_16x16x32_bf16 v[196:199], v[44:47], a[12:15], v[196:199]
  s_add_u32 s43, s40, s42
  buffer_load_dwordx4 v[40:43], v1, s[8:11], s43 offen sc1
  buffer_load_dwordx4 v[44:47], v1, s[8:11], s43 offen offset:1024 sc1
  s_add_u32 s42, s42, 2048
  s_and_b32 s42, s42, 0xffff
  s_waitcnt vmcnt(30)
  v_mfma_f32_16x16x32_bf16 v[192:195], v[48:51], a[16:19], v[192:195]
  v_mfma_f32_16x16x32_bf16 v[196:199], v[52:55], a[16:19], v[196:199]
  s_add_u32 s43, s40, s42
  buffer_load_dwordx4 v[48:51], v1, s[8:11], s43 offen sc1
  buffer_load_dwordx4 v[52:55], v1, s[8:11], s43 offen offset:1024 sc1
  s_add_u32 s42, s42, 2048
  s_and_b32 s42, s42, 0xffff
  s_waitcnt vmcnt(30)
  v_mfma_f32_16x16x32_bf16 v[192:195], v[56:59], a[20:23], v[192:195]
  v_mfma_f32_16x16x32_bf16 v[196:199], v[60:63], a[20:23], v[196:199]
  s_add_u32 s43, s40, s42
  buffer_load_dwordx4 v[56:59], v1, s[8:11], s43 offen sc1
  buffer_load_dwordx4 v[60:63], v1, s[8:11], s43 offen offset:1024 sc1
  s_add_u32 s42, s42, 2048
  s_and_b32 s42, s42, 0xffff
  s_waitcnt vmcnt(30)
  v_mfma_f32_16x16x32_bf16 v[192:195], v[64:67], a[24:27], v[192:195]
  v_mfma_f32_16x16x32_bf16 v[196:199], v[68:71], a[24:27], v[196:199]
  s_add_u32 s43, s40, s42
  buffer_load_dwordx4 v[64:67], v1, s[8:11], s43 offen sc1
  buffer_load_dwordx4 v[68:71], v1, s[8:11], s43 offen offset:1024 sc1
  s_add_u32 s42, s42, 2048
  s_and_b32 s42, s42, 0xffff
  s_waitcnt vmcnt(30)
  v_mfma_f32_16x16x32_bf16 v[192:195], v[72:75], a[28:31], v[192:195]
  v_mfma_f32_16x16x32_bf16 v[196:199], v[76:79], a[28:31], v[196:199]
  s_add_u32 s43, s40, s42
  buffer_load_dwordx4 v[72:75], v1, s[8:11], s43 offen sc1
  buffer_load_dwordx4 v[76:79], v1, s[8:11], s43 offen offset:1024 sc1
  s_add_u32 s42, s42, 2048
  s_and_b32 s42, s42, 0xffff
  s_waitcnt vmcnt(30)
  v_mfma_f32_16x16x32_bf16 v[192:195], v[80:83], a[32:35], v[192:195]
  v_mfma_f32_16x16x32_bf16 v[196:199], v[84:87], a[32:35], v[196:199]
  s_add_u32 s43, s40, s42
  buffer_load_dwordx4 v[80:83], v1, s[8:11], s43 offen sc1
  buffer_load_dwordx4 v[84:87], v1, s[8:11], s43 offen offset:1024 sc1
  s_add_u32 s42, s42, 2048
  s_and_b32 s42, s42, 0xffff
  s_waitcnt vmcnt(30)
  v_mfma_f32_16x16x32_bf16 v[192:195], v[88:91], a[36:39], v[192:195]
  v_mfma_f32_16x16x32_bf16 v[196:199], v[92:95], a[36:39], v[196:199]
  s_add_u32 s43, s40, s42
  buffer_load_dwordx4 v[88:91], v1, s[8:11], s43 offen sc1
  buffer_load_dwordx4 v[92:95], v1, s[8:11], s43 offen offset:1024 sc1
  s_add_u32 s42, s42, 2048
  s_and_b32 s42, s42, 0xffff
  s_waitcnt vmcnt(30)
  v_mfma_f32_16x16x32_bf16 v[192:195], v[96:99], a[40:43], v[192:195]
  v_mfma_f32_16x16x32_bf16 v[196:199], v[100:103], a[40:43], v[196:199]
  s_add_u32 s43, s40, s42
  buffer_load_dwordx4 v[96:99], v1, s[8:11], s43 offen sc1
  buffer_load_dwordx4 v[100:103], v1, s[8:11], s43 offen offset:1024 sc1
  s_add_u32 s42, s42, 2048
  s_and_b32 s42, s42, 0xffff
  s_waitcnt vmcnt(30)
  v_mfma_f32_16x16x32_bf16 v[192:195], v[104:107], a[44:47], v[192:195]
  v_mfma_f32_16x16x32_bf16 v[196:199], v[108:111], a[44:47], v[196:199]
  s_add_u32 s43, s40, s42
  buffer_load_dwordx4 v[104:107], v1, s[8:11], s43 offen sc1
  buffer_load_dwordx4 v[108:111], v1, s[8:11], s43 offen offset:1024 sc1
  s_add_u32 s42, s42, 2048
  s_and_b32 s42, s42, 0xffff
  s_waitcnt vmcnt(30)
  v_mfma_f32_16x16x32_bf16 v[192:195], v[112:115], a[48:51], v[192:195]
  v_mfma_f32_16x16x32_bf16 v[196:199], v[116:119], a[48:51], v[196:199]
  s_add_u32 s43, s40, s42
  buffer_load_dwordx4 v[112:115], v1, s[8:11], s43 offen sc1
  buffer_load_dwordx4 v[116:119], v1, s[8:11], s43 offen offset:1024 sc1
  s_add_u32 s42, s42, 2048
  s_and_b32 s42, s42, 0xffff
  s_waitcnt vmcnt(30)
  v_mfma_f32_16x16x32_bf16 v[192:195], v[120:123], a[52:55], v[192:195]
  v_mfma_f32_16x16x32_bf16 v[196:199], v[124:127], a[52:55], v[196:199]
  s_add_u32 s43, s40, s42
  buffer_load_dwordx4 v[120:123], v1, s[8:11], s43 offen sc1
  buffer_load_dwordx4 v[124:127], v1, s[8:11], s43 offen offset:1024 sc1
  s_add_u32 s42, s42, 2048
  s_and_b32 s42, s42, 0xffff
  s_waitcnt vmcnt(30)
  v_mfma_f32_16x16x32_bf16 v[192:195], v[128:131], a[56:59], v[192:195]
  v_mfma_f32_16x16x32_bf16 v[196:199], v[132:135], a[56:59], v[196:199]
  s_add_u32 s43, s40, s42
  buffer_load_dwordx4 v[128:131], v1, s[8:11], s43 offen sc1
  buffer_load_dwordx4 v[132:135], v1, s[8:11], s43 offen offset:1024 sc1
  s_add_u32 s42, s42, 2048
  s_and_b32 s42, s42, 0xffff
  s_waitcnt vmcnt(30)
  v_mfma_f32_16x16x32_bf16 v[192:195], v[136:139], a[60:63], v[192:195]
  v_mfma_f32_16x16x32_bf16 v[196:199], v[140:143], a[60:63], v[196:199]
  s_add_u32 s43, s40, s42
  buffer_load_dwordx4 v[136:139], v1, s[8:11], s43 offen sc1
  buffer_load_dwordx4 v[140:143], v1, s[8:11], s43 offen offset:1024 sc1
  s_add_u32 s42, s42, 2048
  s_and_b32 s42, s42, 0xffff
  s_waitcnt vmcnt(30)
  v_mfma_f32_16x16x32_bf16 v[192:195], v[16:19], a[64:67], v[192:195]
  v_mfma_f32_16x16x32_bf16 v[196:199], v[20:23], a[64:67], v[196:199]
  buffer_load_dwordx4 v[16:19], v1, s[8:11], s41 offen sc1
  buffer_load_dwordx4 v[20:23], v1, s[8:11], s41 offen offset:1024 sc1
  s_add_u32 s41, s41, 2048
  s_waitcnt vmcnt(30)
  v_mfma_f32_16x16x32_bf16 v[192:195], v[24:27], a[68:71], v[192:195]
  v_mfma_f32_16x16x32_bf16 v[196:199], v[28:31], a[68:71], v[196:199]
  buffer_load_dwordx4 v[24:27], v1, s[8:11], s41 offen sc1
  buffer_load_dwordx4 v[28:31], v1, s[8:11], s41 offen offset:1024 sc1
  s_add_u32 s41, s41, 2048
  s_waitcnt vmcnt(30)
  v_mfma_f32_16x16x32_bf16 v[192:195], v[32:35], a[72:75], v[192:195]
  v_mfma_f32_16x16x32_bf16 v[196:199], v[36:39], a[72:75], v[196:199]
  buffer_load_dwordx4 v[32:35], v1, s[8:11], s41 offen sc1
  buffer_load_dwordx4 v[36:39], v1, s[8:11], s41 offen offset:1024 sc1
  s_add_u32 s41, s41, 2048
  s_waitcnt vmcnt(30)
  v_mfma_f32_16x16x32_bf16 v[192:195], v[40:43], a[76:79], v[192:195]
  v_mfma_f32_16x16x32_bf16 v[196:199], v[44:47], a[76:79], v[196:199]
  buffer_load_dwordx4 v[40:43], v1, s[8:11], s41 offen sc1
  buffer_load_dwordx4 v[44:47], v1, s[8:11], s41 offen offset:1024 sc1
  s_add_u32 s41, s41, 2048
  s_waitcnt vmcnt(30)
  v_mfma_f32_16x16x32_bf16 v[192:195], v[48:51], a[80:83], v[192:195]
  v_mfma_f32_16x16x32_bf16 v[196:199], v[52:55], a[80:83], v[196:199]
  s_waitcnt vmcnt(28)
  v_mfma_f32_16x16x32_bf16 v[192:195], v[56:59], a[84:87], v[192:195]
  v_mfma_f32_16x16x32_bf16 v[196:199], v[60:63], a[84:87], v[196:199]
  s_waitcnt vmcnt(26)
  v_mfma_f32_16x16x32_bf16 v[192:195], v[64:67], a[88:91], v[192:195]
  v_mfma_f32_16x16x32_bf16 v[196:199], v[68:71], a[88:91], v[196:199]
  s_waitcnt vmcnt(24)
  v_mfma_f32_16x16x32_bf16 v[192:195], v[72:75], a[92:95], v[192:195]
  v_mfma_f32_16x16x32_bf16 v[196:199], v[76:79], a[92:95], v[196:199]
  s_waitcnt vmcnt(22)
  v_mfma_f32_16x16x32_bf16 v[192:195], v[80:83], a[96:99], v[192:195]
  v_mfma_f32_16x16x32_bf16 v[196:199], v[84:87], a[96:99], v[196:199]
  s_waitcnt vmcnt(20)
  v_mfma_f32_16x16x32_bf16 v[192:195], v[88:91], a[100:103], v[192:195]
  v_mfma_f32_16x16x32_bf16 v[196:199], v[92:95], a[100:103], v[196:199]
  s_waitcnt vmcnt(18)
  v_mfma_f32_16x16x32_bf16 v[192:195], v[96:99], a[104:107], v[192:195]
  v_mfma_f32_16x16x32_bf16 v[196:199], v[100:103], a[104:107], v[196:199]
  s_waitcnt vmcnt(16)
  v_mfma_f32_16x16x32_bf16 v[192:195], v[104:107], a[108:111], v[192:195]
  v_mfma_f32_16x16x32_bf16 v[196:199], v[108:111], a[108:111], v[196:199]
  s_waitcnt vmcnt(14)
  v_mfma_f32_16x16x32_bf16 v[192:195], v[112:115], a[112:115], v[192:195]
  v_mfma_f32_16x16x32_bf16 v[196:199], v[116:119], a[112:115], v[196:199]
  s_waitcnt vmcnt(12)
  v_mfma_f32_16x16x32_bf16 v[192:195], v[120:123], a[116:119], v[192:195]
  v_mfma_f32_16x16x32_bf16 v[196:199], v[124:127], a[116:119], v[196:199]
  s_waitcnt vmcnt(10)
  v_mfma_f32_16x16x32_bf16 v[192:195], v[128:131], a[120:123], v[192:195]
  v_mfma_f32_16x16x32_bf16 v[196:199], v[132:135], a[120:123], v[196:199]
  s_waitcnt vmcnt(8)
  v_mfma_f32_16x16x32_bf16 v[192:195], v[136:139], a[124:127], v[192:195]
  v_mfma_f32_16x16x32_bf16 v[196:199], v[140:143], a[124:127], v[196:199]
  s_waitcnt vmcnt(6)
  v_mfma_f32_16x16x32_bf16 v[192:195], v[16:19], a[128:131], v[192:195]
  v_mfma_f32_16x16x32_bf16 v[196:199], v[20:23], a[128:131], v[196:199]
  s_waitcnt vmcnt(4)
  v_mfma_f32_16x16x32_bf16 v[192:195], v[24:27], a[132:135], v[192:195]
  v_mfma_f32_16x16x32_bf16 v[196:199], v[28:31], a[132:135], v[196:199]
  s_waitcnt vmcnt(2)
  v_mfma_f32_16x16x32_bf16 v[192:195], v[32:35], a[136:139], v[192:195]
  v_mfma_f32_16x16x32_bf16 v[196:199], v[36:39], a[136:139], v[196:199]
  s_waitcnt vmcnt(0)
  v_mfma_f32_16x16x32_bf16 v[192:195], v[40:43], a[140:143], v[192:195]
  v_mfma_f32_16x16x32_bf16 v[196:199], v[44:47], a[140:143], v[196:199]
  s_lshl_b32 s40, s21, 11
  s_add_u32 s40, s40, 8192
  v_add_u32 v10, s40, v1
  s_nop 7
  ds_write_b128 v10, v[192:195]
  ds_write_b128 v10, v[196:199] offset:1024
  s_waitcnt lgkmcnt(0)
  s_barrier
  s_cmp_lt_u32 s21, 2
  s_cbranch_scc0 F_NOST
  s_lshl_b32 s40, s21, 10
  s_add_u32 s40, s40, 8192
  v_add_u32 v10, s40, v1
  ds_read_b128 v[16:19], v10 offset:0
  ds_read_b128 v[20:23], v10 offset:2048
  ds_read_b128 v[24:27], v10 offset:4096
  ds_read_b128 v[28:31], v10 offset:6144
  s_waitcnt lgkmcnt(0)
  v_add_f32 v16, v16, v20
  v_add_f32 v24, v24, v28
  v_add_f32 v17, v17, v21
  v_add_f32 v25, v25, v29
  v_add_f32 v18, v18, v22
  v_add_f32 v26, v26, v30
  v_add_f32 v19, v19, v23
  v_add_f32 v27, v27, v31
  v_add_f32 v16, v16, v24
  v_add_f32 v17, v17, v25
  v_add_f32 v18, v18, v26
  v_add_f32 v19, v19, v27
  v_cvt_pk_bf16_f32 v16, v16, v16
  v_cvt_pk_bf16_f32 v17, v17, v17
  v_cvt_pk_bf16_f32 v18, v18, v18
  v_cvt_pk_bf16_f32 v19, v19, v19
  s_lshl_b32 s40, s24, 15
  s_lshl_b32 s41, s21, 14
  s_add_u32 s40, s40, s41
  buffer_store_short v16, v8, s[12:15], s40 offen offset:0
  buffer_store_short v17, v8, s[12:15], s40 offen offset:1024
  buffer_store_short v18, v8, s[12:15], s40 offen offset:2048
  buffer_store_short v19, v8, s[12:15], s40 offen offset:3072
F_NOST:
  s_barrier
  s_mov_b32 s24, s26
  s_cmp_lt_u32 s24, 64
  s_cbranch_scc1 F_LOOP
F_DONE:
  s_waitcnt vmcnt(0)
  s_mov_b32 s16, s88
  s_and_b32 s17, s89, 0xffff
  s_mov_b32 s18, 0x100
  s_mov_b32 s19, 0x20000
  s_waitcnt vmcnt(0)
  s_branch K_END
K_ABORT:
  s_waitcnt vmcnt(0) lgkmcnt(0)
  s_lshl_b32 s40, s95, 2
  s_add_u32 s40, s40, s21
  s_lshl_b32 s40, s40, 3
  s_add_u32 s40, s40, 60817408
  v_mov_b32 v2, s96
  v_mov_b32 v3, s97
  v_mov_b32 v4, 0
  s_mov_b64 exec, 1
  buffer_store_dwordx2 v[2:3], v4, s[8:11], s40 offen
  s_waitcnt vmcnt(0)
K_END:
  s_endpgm
  .section .rodata,"a"
  .p2align 6
  .amdhsa_kernel gated_mix__memory_aug_recurrent_mem_tr__grouped_kv_mqa__prompt_kernel
  .amdhsa_next_free_vgpr 512
  .amdhsa_next_free_sgpr 102
  .amdhsa_accum_offset 256
  .amdhsa_group_segment_fixed_size 0
  .amdhsa_kernarg_size 128
  .amdhsa_user_sgpr_count 2
  .amdhsa_user_sgpr_kernarg_segment_ptr 1
  .amdhsa_system_sgpr_workgroup_id_x 1
  .end_amdhsa_kernel
```
